```python
import torch

def _softmax(x, axis=-1):
    return torch.softmax(x, dim=axis)
def _gelu(x):
    return torch.nn.functional.gelu(x, approximate="tanh")
def _silu(x):
    return torch.nn.functional.silu(x)
def _sigmoid(x):
    return torch.sigmoid(x)
def _layernorm(x, axis=-1, eps=1e-5):
    m = x.mean(dim=axis, keepdim=True)
    v = x.var(dim=axis, keepdim=True, unbiased=False)
    return (x - m) / torch.sqrt(v + eps)
def _scatter_add(tgt, idx, src, axis=0):
    return tgt.clone().index_add_(axis, idx, src)
def _segment_sum(src, seg, n):
    out = torch.zeros((n,) + src.shape[1:], dtype=src.dtype)
    return out.index_add_(0, seg, src)
def _pad(x, pw):
    flat = tuple(v for pair in reversed(pw) for v in pair)
    return torch.nn.functional.pad(x, flat)

kernel_name = 'parallel_sum__sliding_block_cached__dense_activation_mish__decode'

def setup_inputs():

    _w = (lambda a: (lambda t: t.to(torch.bfloat16) if t.is_floating_point() else t)(torch.as_tensor(a)))
    def _A_setup():
        B, Sq, D = 4, 1, 448
        Hq, Hkv, Sk, Dh = 16, 8, 4096, 256
        assert Hq % Hkv == 0, (Hq, Hkv)
        return {
            "x": _w((lambda *s: torch.randn(*s, dtype=torch.bfloat16) * 0.05)(B, Sq, D)),
            "k_cache": _w((lambda *s: torch.randn(*s, dtype=torch.bfloat16) * 1.6)(B, Hkv, Sk, Dh)),
            "v_cache": _w((lambda *s: torch.randn(*s, dtype=torch.bfloat16) * 0.4)(B, Hkv, Sk, Dh)),
            "wq": _w((lambda *s: torch.randn(*s, dtype=torch.bfloat16) * 1.6)(D, Hq * Dh) * (D ** -0.5)),
            "wo": _w((lambda *s: torch.randn(*s, dtype=torch.bfloat16) * 0.4)(Hq * Dh, D) * ((Hq * Dh) ** -0.5)),
        }
    _A_in = _A_setup()

    def _B_setup():
        B, S, D, F = 4, 1, 448, 1792
        return {
            "x": _w((lambda *s: torch.randn(*s, dtype=torch.bfloat16) * 0.05)(B, S, D)),
            "w1": _w((lambda *s: torch.randn(*s, dtype=torch.bfloat16) * 0.8)(D, F) * (D ** -0.5)),
            "b1": _w((lambda *s: torch.randn(*s, dtype=torch.bfloat16) * 0.2)(F)),
            "w2": _w((lambda *s: torch.randn(*s, dtype=torch.bfloat16) * 0.1)(F, D) * (F ** -0.5)),
        }
    _B_in = _B_setup()

    return {
        "A_x": _A_in["x"],
        "A_k_cache": _A_in["k_cache"],
        "A_v_cache": _A_in["v_cache"],
        "A_wq": _A_in["wq"],
        "A_wo": _A_in["wo"],
        "B_x": _B_in["x"],
        "B_w1": _B_in["w1"],
        "B_b1": _B_in["b1"],
        "B_w2": _B_in["w2"],
    }

def reference(A_x, A_k_cache, A_v_cache, A_wq, A_wo, B_x, B_w1, B_b1, B_w2):
    def _A_ref(x, k_cache, v_cache, wq, wo):
        B, Sq, D = x.shape
        Hq, Dh = 16, 256
        Hkv, Sk = k_cache.shape[1], k_cache.shape[2]
        W = min(4096, max(256, Sk // 4))
        rep = Hq // Hkv
        q = (lambda x, *d: x.permute(*d))((x @ wq).reshape(B, Sq, Hq, Dh), 0, 2, 1, 3)
        k = (lambda x, n, axis: torch.repeat_interleave(x, n, dim=axis))(k_cache[:, :, Sk - W:, :], rep, axis=1)
        v = (lambda x, n, axis: torch.repeat_interleave(x, n, dim=axis))(v_cache[:, :, Sk - W:, :], rep, axis=1)
        scores = torch.einsum("bhqd,bhkd->bhqk", q, k) * (Dh ** -0.5)
        p = _softmax(scores, axis=-1)
        o = torch.einsum("bhqk,bhkd->bhqd", p, v)
        return (lambda x, *d: x.permute(*d))(o, 0, 2, 1, 3).reshape(B, Sq, Hq * Dh) @ wo

    def _B_ref(x, w1, b1, w2):
        h = torch.einsum("bsd,df->bsf", x, w1) + b1
        sp = torch.log1p(torch.exp(-torch.abs(h))) + torch.where(h > 0, h, torch.zeros_like(h))
        act = h * torch.tanh(sp)
        return torch.einsum("bsf,fd->bsd", act, w2)

    x = A_x
    xn = _layernorm(x, axis=-1)
    return x + _A_ref(xn, A_k_cache, A_v_cache, A_wq, A_wo) + _B_ref(xn, B_w1, B_b1, B_w2)
```

```asm
; @launch grid=(256,1,1) block=(1024,1,1) lds=103424
.amdgcn_target "amdgcn-amd-amdhsa--gfx950"
.text
.globl parallel_sum__sliding_block_cached__dense_activation_mish__decode_kernel
.p2align 12
.p2align 8
.type parallel_sum__sliding_block_cached__dense_activation_mish__decode_kernel,@function
parallel_sum__sliding_block_cached__dense_activation_mish__decode_kernel:
    s_cmp_ge_u32 s2, 256
    s_cbranch_scc1 L_end
    s_load_dwordx16 s[4:19], s[0:1], 0
    s_load_dwordx8 s[20:27], s[0:1], 64
    v_lshrrev_b32 v1, 6, v0
    v_and_b32 v0, 63, v0
    s_and_b32 s28, s2, 7
    v_readfirstlane_b32 s3, v1
    s_lshr_b32 s29, s2, 3
    s_and_b32 s50, s3, 3
    s_sub_u32 s46, s3, 4
    s_cmp_ge_u32 s46, 4
    s_cbranch_scc0 L_K
    s_lshr_b32 s30, s29, 3
    s_and_b32 s31, s29, 7
    v_lshrrev_b32 v1, 4, v0
    v_and_b32 v2, 15, v0
    v_mov_b32 v5, 0
    s_cmp_lt_u32 s3, 8
    s_cbranch_scc1 L_lt4
    s_getpc_b64 s[40:41]
L_pc:
    v_lshlrev_b32 v3, 2, v0
    ds_write_b32 v3, v5
    s_cmp_lt_u32 s29, 28
    s_cbranch_scc1 L_nocpf
    s_mul_i32 s46, s3, 1280
    s_sub_u32 s46, s46, 9728
    v_lshl_add_u32 v3, v0, 7, s46
    v_min_u32 v3, L_end-L_pc, v3
    s_mov_b64 exec, 0x3ff
    global_load_dword v120, v3, s[40:41]
    s_mov_b64 exec, -1
L_nocpf:
    s_waitcnt lgkmcnt(0)
    s_barrier
    s_branch L_VW
L_lt4:
    v_lshlrev_b32 v13, 4, v0
    s_mov_b32 s42, 3584
    s_mov_b32 s43, 0x20000
    s_mov_b32 m0, 5120
    s_waitcnt lgkmcnt(0)
    s_mov_b64 s[40:41], s[4:5]
    s_cmp_eq_u32 s3, 3
    s_cbranch_scc0 L_Pn3
    buffer_load_dwordx4 v13, s[40:43], 0 offen offset:0 lds
    buffer_load_dwordx4 v13, s[40:43], 0 offen offset:1024 lds
    buffer_load_dwordx4 v13, s[40:43], 0 offen offset:2048 lds
    buffer_load_dwordx4 v13, s[40:43], 0 offen offset:3072 lds
L_Pn3:
    s_load_dword s44, s[26:27], 0
    s_barrier
    s_branch L_P
L_K:
    s_lshl_b32 s57, s50, 10
    s_add_u32 m0, s57, 9216
    s_mov_b32 s43, 0x20000
    s_sub_u32 s55, s29, 16
    s_cmp_lt_u32 s55, 9
    s_cbranch_scc1 L_Knou
    s_lshr_b32 s51, 0x300000c0, s29
    s_and_b32 s51, s51, 1
    s_mul_i32 s51, s51, 26
    s_xor_b32 s59, s29, s51
    s_mul_i32 s52, s28, 5
    s_add_u32 s52, s52, s59
    s_sub_u32 s52, s52, 25
    s_mul_i32 s53, s52, 43
    s_lshr_b32 s53, s53, 8
    s_lshl_b32 s53, s53, 1
    s_add_u32 s52, s52, s53
    s_lshl_b32 s53, s28, 3
    s_add_u32 s53, s53, s59
    s_sub_u32 s53, s53, 24
    s_cmp_lt_u32 s53, 56
    s_cselect_b32 s53, s53, s52
    s_cmp_ge_u32 s59, 30
    s_cselect_b32 s52, s53, s52
    s_lshl_b32 s53, s28, 4
    s_add_u32 s53, s53, s59
    s_cmp_ge_u32 s59, 25
    s_cselect_b32 s51, 2, 0
    s_cmp_lt_u32 s59, 16
    s_cselect_b32 s51, 1, s51
    s_cselect_b32 s52, s53, s52
    s_and_b32 s53, s52, 1
    s_lshr_b32 s52, s52, 1
    s_cmp_lg_u32 s51, 2
    s_cselect_b32 s54, 16, 7
    s_lshl_b32 s54, s54, 9
    v_lshrrev_b32 v3, 3, v0
    v_mul_u32_u24 v3, s54, v3
    v_and_b32 v4, 7, v0
    v_bfe_u32 v6, v0, 4, 1
    v_lshlrev_b32 v6, 1, v6
    v_xor_b32 v4, v4, v6
    s_and_b32 s55, s50, 1
    s_lshl_b32 s55, s55, 2
    v_xor_b32 v4, s55, v4
    v_lshl_add_u32 v4, v4, 4, v3
    s_mul_i32 s55, s53, 224
    s_lshl_b32 s56, s50, 3
    s_add_u32 s55, s55, s56
    s_mul_i32 s55, s55, s54
    s_lshl_b32 s56, s52, 7
    s_add_u32 s55, s55, s56
    s_lshl_b32 s56, s54, 5
    s_mul_i32 s42, s54, 448
    s_cmp_lg_u32 s51, 2
    s_branch L_Kiss
L_Knou:
    s_lshl_b32 s55, s55, 2
    s_add_u32 s55, s55, s50
    s_mul_i32 s56, s55, 6
    s_cmp_ge_u32 s55, 18
    s_cselect_b32 s57, 116, 0
    s_add_u32 s57, s57, 116
    s_add_u32 s56, s56, s57
    s_lshl_b32 s55, s56, 13
    s_add_u32 s42, s55, 49152
    s_lshl_b32 s57, s28, 10
    s_add_u32 s55, s55, s57
    s_mov_b32 s56, 8192
    v_lshlrev_b32 v4, 4, v0
    s_cmp_eq_u32 s56, s56
L_Kiss:
    s_waitcnt lgkmcnt(0)
    s_cselect_b64 s[40:41], s[10:11], s[16:17]
    buffer_load_dwordx4 v4, s[40:43], s55 offen nt lds
    s_add_u32 m0, m0, 4096
    s_add_u32 s55, s55, s56
    buffer_load_dwordx4 v4, s[40:43], s55 offen nt lds
    s_add_u32 m0, m0, 4096
    s_add_u32 s55, s55, s56
    buffer_load_dwordx4 v4, s[40:43], s55 offen nt lds
    s_add_u32 m0, m0, 4096
    s_add_u32 s55, s55, s56
    buffer_load_dwordx4 v4, s[40:43], s55 offen nt lds
    s_add_u32 m0, m0, 4096
    s_add_u32 s55, s55, s56
    buffer_load_dwordx4 v4, s[40:43], s55 offen nt lds
    s_add_u32 m0, m0, 4096
    s_add_u32 s55, s55, s56
    buffer_load_dwordx4 v4, s[40:43], s55 offen nt lds
    s_add_u32 m0, m0, 4096
    s_add_u32 s55, s55, s56
    buffer_load_dwordx4 v4, s[40:43], s55 offen nt lds
    s_lshr_b32 s30, s29, 3
    s_and_b32 s31, s29, 7
    s_lshl_b32 s46, s30, 3
    s_add_u32 s46, s46, s28
    s_lshl_b32 s47, s46, 21
    s_add_u32 s47, s47, 0x180000
    s_and_b32 s49, s28, 1
    s_lshl_b32 s49, s49, 3
    s_lshr_b32 s57, s50, 1
    s_add_u32 s49, s49, s57
    s_add_u32 s48, s49, s31
    s_lshl_b32 s48, s48, 12
    s_lshl_b32 s49, s49, 15
    s_and_b32 s57, s50, 1
    s_lshl_b32 s57, s57, 11
    s_add_u32 s47, s47, s57
    s_add_u32 s32, s6, s47
    s_addc_u32 s33, s7, 0
    s_mov_b32 s34, 522240
    s_mov_b32 s35, 0x20000
    v_lshrrev_b32 v1, 4, v0
    v_bfe_u32 v3, v0, 2, 2
    v_lshlrev_b32 v3, 9, v3
    v_lshl_add_u32 v3, v1, 6, v3
    v_and_b32 v6, 3, v0
    v_lshl_add_u32 v3, v6, 4, v3
    s_and_b32 s54, s49, 0x7ffff
    s_and_b32 s46, s48, 0x7fff
    s_or_b32 s54, s54, s46
    buffer_load_dwordx4 v[64:67], v3, s[32:35], s54 offen offset:0 nt
    buffer_load_dwordx4 v[68:71], v3, s[32:35], s54 offen offset:256 nt
    s_add_u32 s49, s49, 65536
    s_add_u32 s48, s48, 8192
    s_and_b32 s54, s49, 0x7ffff
    s_and_b32 s46, s48, 0x7fff
    s_or_b32 s54, s54, s46
    buffer_load_dwordx4 v[72:75], v3, s[32:35], s54 offen offset:0 nt
    s_lshl_b32 s58, s50, 2
    v_mov_b32 v9, s58
    v_mov_b32 v8, 1
    v_mov_b32 v5, 0
    s_barrier
    s_waitcnt vmcnt(5)
    buffer_load_dwordx4 v[76:79], v3, s[32:35], s54 offen offset:256 nt
    s_add_u32 s49, s49, 65536
    s_add_u32 s48, s48, 8192
    s_and_b32 s54, s49, 0x7ffff
    s_and_b32 s46, s48, 0x7fff
    s_or_b32 s54, s54, s46
    s_waitcnt vmcnt(5)
    buffer_load_dwordx4 v[80:83], v3, s[32:35], s54 offen offset:0 nt
    s_waitcnt vmcnt(5)
    ds_write_b32 v9, v8 offset:64
    buffer_load_dwordx4 v[84:87], v3, s[32:35], s54 offen offset:256 nt
    s_add_u32 s49, s49, 65536
    s_add_u32 s48, s48, 8192
    s_and_b32 s54, s49, 0x7ffff
    s_and_b32 s46, s48, 0x7fff
    s_or_b32 s54, s54, s46
    s_waitcnt vmcnt(5)
    buffer_load_dwordx4 v[88:91], v3, s[32:35], s54 offen offset:0 nt
    s_waitcnt vmcnt(5)
    buffer_load_dwordx4 v[92:95], v3, s[32:35], s54 offen offset:256 nt
    s_add_u32 s49, s49, 65536
    s_add_u32 s48, s48, 8192
    s_and_b32 s54, s49, 0x7ffff
    s_and_b32 s46, s48, 0x7fff
    s_or_b32 s54, s54, s46
    s_waitcnt vmcnt(5)
    buffer_load_dwordx4 v[96:99], v3, s[32:35], s54 offen offset:0 nt
    s_waitcnt vmcnt(5)
    buffer_load_dwordx4 v[100:103], v3, s[32:35], s54 offen offset:256 nt
    s_add_u32 s49, s49, 65536
    s_add_u32 s48, s48, 8192
    s_and_b32 s54, s49, 0x7ffff
    s_and_b32 s46, s48, 0x7fff
    s_or_b32 s54, s54, s46
    s_waitcnt vmcnt(5)
    buffer_load_dwordx4 v[104:107], v3, s[32:35], s54 offen offset:0 nt
    s_waitcnt vmcnt(5)
    buffer_load_dwordx4 v[108:111], v3, s[32:35], s54 offen offset:256 nt
    s_add_u32 s49, s49, 65536
    s_add_u32 s48, s48, 8192
    s_and_b32 s54, s49, 0x7ffff
    s_and_b32 s46, s48, 0x7fff
    s_or_b32 s54, s54, s46
    s_waitcnt vmcnt(5)
    buffer_load_dwordx4 v[112:115], v3, s[32:35], s54 offen offset:0 nt
    s_waitcnt vmcnt(5)
    buffer_load_dwordx4 v[116:119], v3, s[32:35], s54 offen offset:256 nt
    s_add_u32 s49, s49, 65536
    s_add_u32 s48, s48, 8192
    s_and_b32 s54, s49, 0x7ffff
    s_and_b32 s46, s48, 0x7fff
    s_or_b32 s54, s54, s46
    s_waitcnt vmcnt(5)
    buffer_load_dwordx4 v[120:123], v3, s[32:35], s54 offen offset:0 nt
    s_waitcnt vmcnt(5)
    buffer_load_dwordx4 v[124:127], v3, s[32:35], s54 offen offset:256 nt
    v_mov_b32 v8, 1
    s_waitcnt vmcnt(5)
    ds_write_b32 v9, v8 offset:48
    v_mov_b32 v8, 2
    s_waitcnt vmcnt(4)
    ds_write_b32 v9, v8 offset:48
    v_mov_b32 v8, 3
    s_waitcnt vmcnt(3)
    ds_write_b32 v9, v8 offset:48
    v_mov_b32 v8, 4
    s_waitcnt vmcnt(2)
    ds_write_b32 v9, v8 offset:48
    v_mov_b32 v8, 5
    s_waitcnt vmcnt(1)
    ds_write_b32 v9, v8 offset:48
    v_mov_b32 v8, 6
    s_waitcnt vmcnt(0)
    ds_write_b32 v9, v8 offset:48
    v_bfe_u32 v18, v0, 2, 1
    v_lshlrev_b32 v7, 9, v18
    v_lshl_add_u32 v7, v1, 6, v7
    s_lshr_b32 s56, s50, 1
    s_lshl_b32 s58, s56, 5
    s_and_b32 s57, s50, 1
    s_lshl_b32 s57, s57, 8
    s_add_u32 s57, s58, s57
    v_add_u32 v7, s57, v7
    v_mov_b32 v16, v9
    v_mov_b32 v17, 1
    v_lshlrev_b32 v18, 5, v18
    s_lshl_b32 s57, s50, 3
    v_add_u32 v19, s57, v18
    v_add_u32 v6, v9, v18
    s_mov_b32 s59, 0x3db8aa3b
    s_mov_b32 s45, 320000
L_lwk:
    s_sleep 1
    ds_read_b32 v8, v5 offset:4
    s_sub_u32 s45, s45, 1
    s_cbranch_scc1 L_lwdk
    s_waitcnt lgkmcnt(0)
    v_readfirstlane_b32 s44, v8
    s_cmp_lt_u32 s44, 1
    s_cbranch_scc1 L_lwk
L_lwdk:
    ds_read_b128 v[8:11], v3 offset:2304
    ds_read_b128 v[12:15], v3 offset:2560
    s_waitcnt lgkmcnt(0)
    v_mfma_f32_16x16x32_bf16 v[24:27], v[64:67], v[8:11], 0
    s_nop 0
    s_nop 0
    v_mfma_f32_16x16x32_bf16 v[24:27], v[68:71], v[12:15], v[24:27]
    s_nop 0
    s_nop 0
    v_mfma_f32_16x16x32_bf16 v[28:31], v[72:75], v[8:11], 0
    s_nop 0
    s_nop 0
    v_mfma_f32_16x16x32_bf16 v[28:31], v[76:79], v[12:15], v[28:31]
    s_nop 0
    s_nop 0
    v_mfma_f32_16x16x32_bf16 v[32:35], v[80:83], v[8:11], 0
    v_mov_b32_dpp v56, v24 quad_perm:[0,0,0,0] row_mask:0xf bank_mask:0xf
    s_nop 0
    v_mfma_f32_16x16x32_bf16 v[32:35], v[84:87], v[12:15], v[32:35]
    v_add_f32_dpp v56, v25, v56 quad_perm:[1,1,1,1] row_mask:0xf bank_mask:0xf
    s_nop 0
    v_mfma_f32_16x16x32_bf16 v[36:39], v[88:91], v[8:11], 0
    v_add_f32_dpp v56, v26, v56 quad_perm:[2,2,2,2] row_mask:0xf bank_mask:0xf
    v_mov_b32_dpp v57, v28 quad_perm:[0,0,0,0] row_mask:0xf bank_mask:0xf
    v_mfma_f32_16x16x32_bf16 v[36:39], v[92:95], v[12:15], v[36:39]
    v_add_f32_dpp v56, v27, v56 quad_perm:[3,3,3,3] row_mask:0xf bank_mask:0xf
    v_add_f32_dpp v57, v29, v57 quad_perm:[1,1,1,1] row_mask:0xf bank_mask:0xf
    v_mfma_f32_16x16x32_bf16 v[40:43], v[96:99], v[8:11], 0
    v_add_f32_dpp v56, v56, v56 row_ror:8 row_mask:0xf bank_mask:0xf
    v_add_f32_dpp v57, v30, v57 quad_perm:[2,2,2,2] row_mask:0xf bank_mask:0xf
    v_mfma_f32_16x16x32_bf16 v[40:43], v[100:103], v[12:15], v[40:43]
    v_mov_b32_dpp v58, v32 quad_perm:[0,0,0,0] row_mask:0xf bank_mask:0xf
    v_add_f32_dpp v57, v31, v57 quad_perm:[3,3,3,3] row_mask:0xf bank_mask:0xf
    v_mfma_f32_16x16x32_bf16 v[44:47], v[104:107], v[8:11], 0
    v_add_f32_dpp v58, v33, v58 quad_perm:[1,1,1,1] row_mask:0xf bank_mask:0xf
    v_add_f32_dpp v57, v57, v57 row_ror:8 row_mask:0xf bank_mask:0xf
    v_mfma_f32_16x16x32_bf16 v[44:47], v[108:111], v[12:15], v[44:47]
    v_add_f32_dpp v58, v34, v58 quad_perm:[2,2,2,2] row_mask:0xf bank_mask:0xf
    v_mov_b32_dpp v59, v36 quad_perm:[0,0,0,0] row_mask:0xf bank_mask:0xf
    v_mfma_f32_16x16x32_bf16 v[48:51], v[112:115], v[8:11], 0
    v_add_f32_dpp v58, v35, v58 quad_perm:[3,3,3,3] row_mask:0xf bank_mask:0xf
    v_add_f32_dpp v59, v37, v59 quad_perm:[1,1,1,1] row_mask:0xf bank_mask:0xf
    v_mfma_f32_16x16x32_bf16 v[48:51], v[116:119], v[12:15], v[48:51]
    v_add_f32_dpp v58, v58, v58 row_ror:8 row_mask:0xf bank_mask:0xf
    v_add_f32_dpp v59, v38, v59 quad_perm:[2,2,2,2] row_mask:0xf bank_mask:0xf
    v_mfma_f32_16x16x32_bf16 v[52:55], v[120:123], v[8:11], 0
    v_mov_b32_dpp v60, v40 quad_perm:[0,0,0,0] row_mask:0xf bank_mask:0xf
    v_add_f32_dpp v59, v39, v59 quad_perm:[3,3,3,3] row_mask:0xf bank_mask:0xf
    v_mfma_f32_16x16x32_bf16 v[52:55], v[124:127], v[12:15], v[52:55]
    v_add_f32_dpp v60, v41, v60 quad_perm:[1,1,1,1] row_mask:0xf bank_mask:0xf
    v_add_f32_dpp v59, v59, v59 row_ror:8 row_mask:0xf bank_mask:0xf
    v_mov_b32_dpp v61, v44 quad_perm:[0,0,0,0] row_mask:0xf bank_mask:0xf
    v_add_f32_dpp v60, v42, v60 quad_perm:[2,2,2,2] row_mask:0xf bank_mask:0xf
    v_mov_b32_dpp v62, v48 quad_perm:[0,0,0,0] row_mask:0xf bank_mask:0xf
    v_add_f32_dpp v61, v45, v61 quad_perm:[1,1,1,1] row_mask:0xf bank_mask:0xf
    v_add_f32_dpp v60, v43, v60 quad_perm:[3,3,3,3] row_mask:0xf bank_mask:0xf
    v_add_f32_dpp v62, v49, v62 quad_perm:[1,1,1,1] row_mask:0xf bank_mask:0xf
    v_add_f32_dpp v61, v46, v61 quad_perm:[2,2,2,2] row_mask:0xf bank_mask:0xf
    v_add_f32_dpp v60, v60, v60 row_ror:8 row_mask:0xf bank_mask:0xf
    v_add_f32_dpp v62, v50, v62 quad_perm:[2,2,2,2] row_mask:0xf bank_mask:0xf
    v_add_f32_dpp v61, v47, v61 quad_perm:[3,3,3,3] row_mask:0xf bank_mask:0xf
    v_mov_b32_dpp v63, v52 quad_perm:[0,0,0,0] row_mask:0xf bank_mask:0xf
    v_add_f32_dpp v62, v51, v62 quad_perm:[3,3,3,3] row_mask:0xf bank_mask:0xf
    v_add_f32_dpp v61, v61, v61 row_ror:8 row_mask:0xf bank_mask:0xf
    v_add_f32_dpp v63, v53, v63 quad_perm:[1,1,1,1] row_mask:0xf bank_mask:0xf
    v_add_f32_dpp v62, v62, v62 row_ror:8 row_mask:0xf bank_mask:0xf
    s_nop 0
    v_add_f32_dpp v63, v54, v63 quad_perm:[2,2,2,2] row_mask:0xf bank_mask:0xf
    s_nop 0
    s_nop 0
    v_add_f32_dpp v63, v55, v63 quad_perm:[3,3,3,3] row_mask:0xf bank_mask:0xf
    s_nop 0
    s_nop 0
    v_add_f32_dpp v63, v63, v63 row_ror:8 row_mask:0xf bank_mask:0xf
    v_max3_f32 v12, v56, v57, v58
    v_max3_f32 v12, v12, v59, v60
    v_max3_f32 v12, v12, v61, v62
    v_max_f32 v12, v12, v63
    v_mov_b32 v14, v12
    s_nop 1
    v_permlane32_swap_b32 v12, v14
    v_max_f32 v12, v12, v14
    v_mov_b32 v14, v12
    s_nop 1
    v_permlane16_swap_b32 v12, v14
    v_max_f32 v12, v12, v14
    v_mov_b32 v13, 1
    ds_write_b64 v19, v[12:13] offset:192
    s_mov_b32 s45, 320000
L_kx:
    ds_read_b128 v[20:23], v18 offset:192
    ds_read_b128 v[24:27], v18 offset:208
    s_sub_u32 s45, s45, 1
    s_cbranch_scc1 L_kxd
    s_waitcnt lgkmcnt(0)
    v_and_b32 v14, v21, v23
    v_and_b32 v15, v25, v27
    v_and_b32 v14, v14, v15
    v_cmp_eq_u32 vcc, 0, v14
    s_cbranch_vccnz L_kx
L_kxd:
    v_max3_f32 v12, v20, v22, v24
    v_max_f32 v12, v12, v26
    v_mul_f32 v12, s59, v12
    v_fma_f32 v56, v56, s59, -v12
    v_fma_f32 v57, v57, s59, -v12
    v_fma_f32 v58, v58, s59, -v12
    v_fma_f32 v59, v59, s59, -v12
    v_fma_f32 v60, v60, s59, -v12
    v_fma_f32 v61, v61, s59, -v12
    v_fma_f32 v62, v62, s59, -v12
    v_fma_f32 v63, v63, s59, -v12
    v_exp_f32 v56, v56
    v_exp_f32 v57, v57
    v_exp_f32 v58, v58
    v_exp_f32 v59, v59
    v_exp_f32 v60, v60
    v_exp_f32 v61, v61
    v_exp_f32 v62, v62
    v_exp_f32 v63, v63
    s_nop 0
    v_add_f32 v13, v56, v57
    v_add_f32 v13, v13, v58
    v_add_f32 v13, v13, v59
    v_add_f32 v13, v13, v60
    v_add_f32 v13, v13, v61
    v_add_f32 v13, v13, v62
    v_add_f32 v13, v13, v63
    v_cvt_pk_bf16_f32 v56, v56, v56
    v_cvt_pk_bf16_f32 v57, v57, v57
    v_cvt_pk_bf16_f32 v58, v58, v58
    v_cvt_pk_bf16_f32 v59, v59, v59
    v_cvt_pk_bf16_f32 v60, v60, v60
    v_cvt_pk_bf16_f32 v61, v61, v61
    v_cvt_pk_bf16_f32 v62, v62, v62
    v_cvt_pk_bf16_f32 v63, v63, v63
    v_mov_b32 v15, v13
    s_nop 1
    v_permlane32_swap_b32 v13, v15
    v_add_f32 v13, v13, v15
    v_mov_b32 v15, v13
    s_nop 1
    v_permlane16_swap_b32 v13, v15
    v_add_f32 v13, v13, v15
    s_mov_b32 exec_lo, 0x00110011
    s_mov_b32 exec_hi, 0x00110011
    ds_write_b128 v7, v[56:59] offset:256
    ds_write_b128 v7, v[60:63] offset:272
    ds_write_b32 v6, v12 offset:128
    ds_write_b32 v6, v13 offset:144
    s_mov_b64 exec, 1
    s_waitcnt lgkmcnt(0)
    ds_write_b32 v16, v17 offset:16
    s_endpgm
L_P:
    s_lshr_b32 s51, 0x300000c0, s29
    s_and_b32 s51, s51, 1
    s_mul_i32 s51, s51, 26
    s_xor_b32 s59, s29, s51
    s_mul_i32 s52, s28, 5
    s_add_u32 s52, s52, s59
    s_sub_u32 s52, s52, 25
    s_mul_i32 s53, s52, 43
    s_lshr_b32 s53, s53, 8
    s_lshl_b32 s53, s53, 1
    s_add_u32 s52, s52, s53
    s_lshl_b32 s53, s28, 3
    s_add_u32 s53, s53, s59
    s_sub_u32 s53, s53, 24
    s_cmp_lt_u32 s53, 56
    s_cselect_b32 s53, s53, s52
    s_cmp_ge_u32 s59, 30
    s_cselect_b32 s52, s53, s52
    s_lshl_b32 s53, s28, 4
    s_add_u32 s53, s53, s59
    s_cmp_ge_u32 s59, 25
    s_cselect_b32 s51, 2, 0
    s_cmp_lt_u32 s59, 16
    s_cselect_b32 s51, 1, s51
    s_cselect_b32 s52, s53, s52
    s_and_b32 s53, s52, 1
    s_lshr_b32 s52, s52, 1
    s_mov_b64 s[36:37], s[26:27]
    s_mov_b32 s38, 2097152
    s_mov_b32 s39, 0x20000
    s_waitcnt lgkmcnt(0)
    s_cmp_eq_u32 s3, 1
    s_cbranch_scc0 L_Pm1
    s_mul_i32 s44, s44, 0x9E3779B5
    s_add_u32 s44, s44, 0x7F4A7C15
    s_cmp_eq_u32 s44, 0
    s_cselect_b32 s44, 0x7F4A7C15, s44
    v_mov_b32 v24, s44
    ds_write_b32 v5, v24 offset:0
    s_getreg_b32 s46, hwreg(HW_REG_XCC_ID)
    s_and_b32 s46, s46, 15
    s_lshl_b32 s47, s28, 12
    s_lshl_b32 s48, s29, 7
    s_add_u32 s48, s48, s47
    s_add_u32 s48, s48, 196608
    v_mov_b32 v8, s46
    v_mov_b32 v9, s44
    v_mov_b32 v10, s46
    v_mov_b32 v11, s44
    s_mov_b64 exec, 0xff
    buffer_store_dwordx4 v[8:11], v13, s[36:39], s48 offen sc1
    s_mov_b64 exec, -1
L_Pm1:
    s_cmp_eq_u32 s51, 0
    s_cbranch_scc1 L_Pdone
    s_cmp_eq_u32 s3, 3
    s_cbranch_scc0 L_Pm3
    v_mov_b32 v16, 0x3f803f80
    v_mov_b32 v17, v16
    v_mov_b32 v18, v16
    v_mov_b32 v19, v16
    ds_write_b128 v13, v[16:19] offset:1280
    v_and_b32 v15, 3, v0
    v_mul_u32_u24 v12, 896, v15
    v_lshrrev_b32 v14, 2, v0
    v_lshl_add_u32 v12, v14, 6, v12
    v_cmp_gt_u32 vcc, 14, v14
    v_mov_b32 v14, 3584
    v_lshlrev_b32 v15, 3, v15
    v_cndmask_b32 v12, v14, v12, vcc
    v_mov_b32 v36, 0
    v_mov_b32 v37, 0
    s_waitcnt vmcnt(0)
    ds_read_b128 v[20:23], v12 offset:5120
    ds_read_b128 v[24:27], v12 offset:5136
    ds_read_b128 v[28:31], v12 offset:5152
    ds_read_b128 v[32:35], v12 offset:5168
    s_waitcnt lgkmcnt(0)
    v_dot2c_f32_bf16 v36, v20, v16
    v_dot2c_f32_bf16 v37, v20, v20
    v_dot2c_f32_bf16 v36, v21, v16
    v_dot2c_f32_bf16 v37, v21, v21
    v_dot2c_f32_bf16 v36, v22, v16
    v_dot2c_f32_bf16 v37, v22, v22
    v_dot2c_f32_bf16 v36, v23, v16
    v_dot2c_f32_bf16 v37, v23, v23
    v_dot2c_f32_bf16 v36, v24, v16
    v_dot2c_f32_bf16 v37, v24, v24
    v_dot2c_f32_bf16 v36, v25, v16
    v_dot2c_f32_bf16 v37, v25, v25
    v_dot2c_f32_bf16 v36, v26, v16
    v_dot2c_f32_bf16 v37, v26, v26
    v_dot2c_f32_bf16 v36, v27, v16
    v_dot2c_f32_bf16 v37, v27, v27
    v_dot2c_f32_bf16 v36, v28, v16
    v_dot2c_f32_bf16 v37, v28, v28
    v_dot2c_f32_bf16 v36, v29, v16
    v_dot2c_f32_bf16 v37, v29, v29
    v_dot2c_f32_bf16 v36, v30, v16
    v_dot2c_f32_bf16 v37, v30, v30
    v_dot2c_f32_bf16 v36, v31, v16
    v_dot2c_f32_bf16 v37, v31, v31
    v_dot2c_f32_bf16 v36, v32, v16
    v_dot2c_f32_bf16 v37, v32, v32
    v_dot2c_f32_bf16 v36, v33, v16
    v_dot2c_f32_bf16 v37, v33, v33
    v_dot2c_f32_bf16 v36, v34, v16
    v_dot2c_f32_bf16 v37, v34, v34
    v_dot2c_f32_bf16 v36, v35, v16
    v_dot2c_f32_bf16 v37, v35, v35
    s_nop 3
    v_add_f32_dpp v36, v36, v36 row_ror:4 row_mask:0xf bank_mask:0xf
    v_add_f32_dpp v37, v37, v37 row_ror:4 row_mask:0xf bank_mask:0xf
    s_nop 1
    v_add_f32_dpp v36, v36, v36 row_ror:8 row_mask:0xf bank_mask:0xf
    v_add_f32_dpp v37, v37, v37 row_ror:8 row_mask:0xf bank_mask:0xf
    s_nop 1
    v_mov_b32 v38, v36
    v_mov_b32 v39, v37
    s_nop 1
    v_permlane16_swap_b32 v36, v38
    v_permlane16_swap_b32 v37, v39
    v_add_f32 v36, v36, v38
    v_add_f32 v37, v37, v39
    v_mov_b32 v38, v36
    v_mov_b32 v39, v37
    s_nop 1
    v_permlane32_swap_b32 v36, v38
    v_permlane32_swap_b32 v37, v39
    v_add_f32 v36, v36, v38
    v_add_f32 v37, v37, v39
    v_mul_f32 v36, 0x3b124925, v36
    v_mul_f32 v37, 0x3b124925, v37
    v_fma_f32 v37, -v36, v36, v37
    v_max_f32 v37, 0, v37
    v_add_f32 v37, 0x3727c5ac, v37
    v_rsq_f32 v37, v37
    v_sub_f32 v36, 0, v36
    v_mov_b32 v40, 1
    ds_write_b64 v15, v[36:37] offset:80
    s_waitcnt lgkmcnt(0)
    ds_write_b32 v5, v40 offset:12
L_Pm3:
    v_lshlrev_b32 v10, 10, v1
    v_lshrrev_b32 v11, 2, v2
    v_lshl_add_u32 v10, v11, 7, v10
    v_and_b32 v11, 3, v0
    v_lshl_add_u32 v10, v11, 3, v10
    v_lshlrev_b32 v12, 3, v11
    v_bfe_u32 v11, v0, 3, 2
    v_xor_b32 v11, s3, v11
    v_lshl_add_u32 v6, v11, 5, v10
    v_mul_u32_u24 v14, 896, v2
    s_mul_i32 s54, s53, 448
    s_add_u32 s54, s54, 5120
    v_add_u32 v14, s54, v14
    v_cmp_gt_u32 vcc, 4, v2
    v_mov_b32 v15, 1280
    s_nop 0
    v_cndmask_b32 v14, v15, v14, vcc
    v_lshl_add_u32 v14, v1, 4, v14
    v_and_b32 v10, 3, v0
    v_lshlrev_b32 v10, 6, v10
    v_and_b32 v11, 12, v0
    v_add_u32 v10, v10, v11
    s_and_b32 s54, s52, 7
    s_lshl_b32 s54, s54, 8
    s_lshl_b32 s55, s53, 11
    s_add_u32 s54, s54, s55
    s_lshl_b32 s55, s3, 6
    s_add_u32 s54, s54, s55
    s_lshl_b32 s55, s28, 14
    s_add_u32 s54, s54, s55
    s_add_u32 s54, s54, 4096
    s_lshl_b32 s55, s52, 11
    s_lshl_b32 s56, s53, 10
    s_add_u32 s55, s55, s56
    s_add_u32 s55, s55, 135168
    s_lshl_b32 s56, s3, 8
    s_add_u32 s55, s55, s56
    s_cmp_eq_u32 s51, 1
    s_cselect_b32 s54, s54, s55
    s_cselect_b32 s56, 12, 6
    v_lshrrev_b32 v11, 2, v2
    v_lshlrev_b32 v11, s56, v11
    v_and_b32 v13, 3, v0
    v_lshl_add_u32 v13, v13, 4, v11
    v_mov_b32 v28, 0
    v_mov_b32 v29, 0
    v_mov_b32 v30, 0
    v_mov_b32 v31, 0
    s_cbranch_scc0 L_npw
    s_mov_b64 exec, 0xffff
    buffer_store_dwordx4 v[28:31], v13, s[36:39], s54 offen
    s_mov_b64 exec, -1
L_npw:
    s_mov_b32 s45, 320000
L_lwp:
    ds_read_b32 v27, v5 offset:0
    s_sub_u32 s45, s45, 1
    s_cbranch_scc1 L_lwdp
    s_waitcnt lgkmcnt(0)
    v_readfirstlane_b32 s44, v27
    s_cmp_lt_u32 s44, 1
    s_cbranch_scc1 L_lwp
L_lwdp:
    s_mov_b32 s45, 320000
L_lwx:
    ds_read_b32 v26, v5 offset:12
    s_sub_u32 s45, s45, 1
    s_cbranch_scc1 L_lwdx
    s_waitcnt lgkmcnt(0)
    v_readfirstlane_b32 s46, v26
    s_cmp_lt_u32 s46, 1
    s_cbranch_scc1 L_lwx
L_lwdx:
    ds_read_b128 v[96:99], v14 offset:0
    ds_read_b128 v[100:103], v14 offset:64
    ds_read_b128 v[104:107], v14 offset:128
    ds_read_b128 v[108:111], v14 offset:192
    ds_read_b128 v[112:115], v14 offset:256
    ds_read_b128 v[116:119], v14 offset:320
    ds_read_b128 v[120:123], v14 offset:384
    ds_read_b64 v[36:37], v12 offset:80
    v_mov_b32 v26, v27
    s_mov_b32 s45, 320000
L_l4pl:
    ds_read_b128 v[16:19], v5 offset:64
    s_sub_u32 s45, s45, 1
    s_cbranch_scc1 L_l4dpl
    s_waitcnt lgkmcnt(0)
    v_and_b32 v16, v16, v17
    v_and_b32 v18, v18, v19
    v_and_b32 v16, v16, v18
    v_cmp_eq_u32 vcc, 0, v16
    s_cbranch_vccnz L_l4pl
L_l4dpl:
    ds_read_b64_tr_b16 v[64:65], v6 offset:9216
    ds_read_b64_tr_b16 v[66:67], v6 offset:9728
    ds_read_b64_tr_b16 v[68:69], v6 offset:13312
    ds_read_b64_tr_b16 v[70:71], v6 offset:13824
    ds_read_b64_tr_b16 v[72:73], v6 offset:17408
    ds_read_b64_tr_b16 v[74:75], v6 offset:17920
    ds_read_b64_tr_b16 v[76:77], v6 offset:21504
    ds_read_b64_tr_b16 v[78:79], v6 offset:22016
    ds_read_b64_tr_b16 v[80:81], v6 offset:25600
    ds_read_b64_tr_b16 v[82:83], v6 offset:26112
    ds_read_b64_tr_b16 v[84:85], v6 offset:29696
    ds_read_b64_tr_b16 v[86:87], v6 offset:30208
    ds_read_b64_tr_b16 v[88:89], v6 offset:33792
    ds_read_b64_tr_b16 v[90:91], v6 offset:34304
    s_waitcnt lgkmcnt(12)
    v_mfma_f32_16x16x32_bf16 v[16:19], v[64:67], v[96:99], 0
    s_waitcnt lgkmcnt(10)
    v_mfma_f32_16x16x32_bf16 v[16:19], v[68:71], v[100:103], v[16:19]
    s_waitcnt lgkmcnt(8)
    v_mfma_f32_16x16x32_bf16 v[16:19], v[72:75], v[104:107], v[16:19]
    s_waitcnt lgkmcnt(6)
    v_mfma_f32_16x16x32_bf16 v[16:19], v[76:79], v[108:111], v[16:19]
    s_waitcnt lgkmcnt(4)
    v_mfma_f32_16x16x32_bf16 v[16:19], v[80:83], v[112:115], v[16:19]
    s_waitcnt lgkmcnt(2)
    v_mfma_f32_16x16x32_bf16 v[16:19], v[84:87], v[116:119], v[16:19]
    s_waitcnt lgkmcnt(0)
    v_mfma_f32_16x16x32_bf16 v[16:19], v[88:91], v[120:123], v[16:19]
    s_nop 7
    v_mov_b32 v20, v16
    v_mov_b32 v21, v17
    v_mov_b32 v22, v18
    v_mov_b32 v23, v19
    v_fmac_f32_dpp v20, v16, v36 row_shl:4 row_mask:0xf bank_mask:0xf
    v_fmac_f32_dpp v21, v17, v36 row_shl:4 row_mask:0xf bank_mask:0xf
    v_fmac_f32_dpp v22, v18, v36 row_shl:4 row_mask:0xf bank_mask:0xf
    v_fmac_f32_dpp v23, v19, v36 row_shl:4 row_mask:0xf bank_mask:0xf
    v_mul_f32 v20, v20, v37
    v_mul_f32 v21, v21, v37
    v_mul_f32 v22, v22, v37
    v_mul_f32 v23, v23, v37
    v_cvt_pk_bf16_f32 v20, v20, v21
    v_cvt_pk_bf16_f32 v21, v22, v23
    ds_bpermute_b32 v24, v10, v20
    ds_bpermute_b32 v25, v10, v21
    s_waitcnt lgkmcnt(0)
    s_mov_b64 exec, 0xffff
    s_cmp_eq_u32 s51, 1
    s_cbranch_scc0 L_Pb
    buffer_store_dwordx4 v[24:27], v13, s[36:39], s54 offen
    v_mov_b32 v32, v24
    v_mov_b32 v33, v25
    v_mov_b32 v34, v26
    v_mov_b32 v35, v27
    s_mov_b32 s59, s54
    s_branch L_Pnb
L_Pb:
    buffer_store_dwordx4 v[24:27], v13, s[36:39], s54 offen sc1
L_Pnb:
    s_mov_b64 exec, -1
L_Pdone:
    v_mov_b32 v36, v13
    s_cmp_eq_u32 s3, 1
    s_cbranch_scc1 L_G
    s_cmp_eq_u32 s3, 0
    s_cbranch_scc0 L_Pw
    s_getreg_b32 s48, hwreg(HW_REG_XCC_ID)
    s_and_b32 s48, s48, 15
    s_lshl_b32 s47, s28, 12
    s_add_u32 s47, s47, 196608
    v_lshlrev_b32 v6, 7, v0
    s_mov_b32 s45, 320000
L_lwxt:
    s_sleep 1
    ds_read_b32 v9, v5 offset:0
    s_sub_u32 s45, s45, 1
    s_cbranch_scc1 L_lwdxt
    s_waitcnt lgkmcnt(0)
    v_readfirstlane_b32 s44, v9
    s_cmp_lt_u32 s44, 1
    s_cbranch_scc1 L_lwxt
L_lwdxt:
    s_mov_b32 s45, 48
L_lwxq:
    s_sleep 2
    ds_read_b32 v10, v5 offset:4
    s_sub_u32 s45, s45, 1
    s_cbranch_scc1 L_lwdxq
    s_waitcnt lgkmcnt(0)
    v_readfirstlane_b32 s49, v10
    s_cmp_lt_u32 s49, 1
    s_cbranch_scc1 L_lwxq
L_lwdxq:
    s_mov_b32 exec_lo, -1
    s_mov_b32 exec_hi, 0
    s_mov_b32 s45, 40000
    s_mov_b32 s49, 2
    s_waitcnt lgkmcnt(0)
L_xpoll:
    buffer_load_dwordx2 v[10:11], v6, s[36:39], s47 offen sc1
    s_sub_u32 s45, s45, 1
    s_waitcnt vmcnt(0)
    s_cbranch_scc1 L_xdone
    v_cmp_ne_u32 vcc, s44, v11
    s_cbranch_vccnz L_xpoll
    v_cmp_ne_u32 vcc, s48, v10
    s_cbranch_vccnz L_xdone
    s_mov_b32 s49, 1
L_xdone:
    v_mov_b32 v8, s49
    ds_write_b32 v5, v8 offset:120
L_Pw:
    s_cmp_eq_u32 s51, 1
    s_cbranch_scc0 L_end
    s_mov_b32 s45, 320000
L_lwpb:
    s_sleep 2
    ds_read_b32 v28, v5 offset:120
    s_sub_u32 s45, s45, 1
    s_cbranch_scc1 L_lwdpb
    s_waitcnt lgkmcnt(0)
    v_readfirstlane_b32 s46, v28
    s_cmp_lt_u32 s46, 1
    s_cbranch_scc1 L_lwpb
L_lwdpb:
    s_cmp_eq_u32 s46, 2
    s_cbranch_scc0 L_qnbc
    s_cmp_eq_u32 s51, 1
    s_cbranch_scc0 L_qnbc
    s_mov_b64 exec, 0xffff
    buffer_store_dwordx4 v[32:35], v36, s[36:39], s59 offen sc1
    s_mov_b64 exec, -1
    s_mov_b32 s51, 0
L_qnbc:
    s_endpgm
L_G:
    v_lshlrev_b32 v6, 4, v0
    v_lshlrev_b32 v7, 3, v0
    s_lshl_b32 s55, s28, 14
    s_lshl_b32 s56, s30, 12
    s_add_u32 s55, s55, s56
    s_add_u32 s55, s55, 4096
    v_mov_b32 v24, s44
    s_mov_b64 s[80:81], -1
    s_mov_b64 s[82:83], -1
    s_mov_b64 s[84:85], -1
    s_mov_b64 s[86:87], -1
    s_mov_b32 s45, 320000
L_lwgp:
    s_sleep 1
    ds_read_b32 v25, v5 offset:64
    s_sub_u32 s45, s45, 1
    s_cbranch_scc1 L_lwdgp
    s_waitcnt lgkmcnt(0)
    v_readfirstlane_b32 s46, v25
    s_cmp_lt_u32 s46, 1
    s_cbranch_scc1 L_lwgp
L_lwdgp:
    s_mov_b32 s45, 40000
L_qpoll:
    ds_read_b32 v25, v5 offset:120
    s_or_b64 exec, s[80:81], 1
    buffer_load_dwordx4 v[64:67], v6, s[36:39], s55 offen offset:0 sc1
    s_or_b64 exec, s[82:83], 1
    buffer_load_dwordx4 v[68:71], v6, s[36:39], s55 offen offset:1024 sc1
    s_or_b64 exec, s[84:85], 1
    buffer_load_dwordx4 v[72:75], v6, s[36:39], s55 offen offset:2048 sc1
    s_or_b64 exec, s[86:87], 1
    buffer_load_dwordx4 v[76:79], v6, s[36:39], s55 offen offset:3072 sc1
    s_waitcnt vmcnt(0)
    s_mov_b64 exec, s[80:81]
    v_cmpx_eq_u32 vcc, s44, v67
    ds_write_b64 v7, v[64:65] offset:2304
    s_andn2_b64 s[80:81], s[80:81], exec
    s_mov_b64 exec, s[82:83]
    v_cmpx_eq_u32 vcc, s44, v71
    ds_write_b64 v7, v[68:69] offset:2816
    s_andn2_b64 s[82:83], s[82:83], exec
    s_mov_b64 exec, s[84:85]
    v_cmpx_eq_u32 vcc, s44, v75
    ds_write_b64 v7, v[72:73] offset:3328
    s_andn2_b64 s[84:85], s[84:85], exec
    s_mov_b64 exec, s[86:87]
    v_cmpx_eq_u32 vcc, s44, v79
    ds_write_b64 v7, v[76:77] offset:3840
    s_andn2_b64 s[86:87], s[86:87], exec
    s_mov_b64 exec, -1
    s_or_b64 s[48:49], s[80:81], s[82:83]
    s_or_b64 s[48:49], s[48:49], s[84:85]
    s_or_b64 s[48:49], s[48:49], s[86:87]
    s_cbranch_scc0 L_qgo
    s_waitcnt lgkmcnt(0)
    v_readfirstlane_b32 s46, v25
    s_cmp_eq_u32 s46, 2
    s_cbranch_scc0 L_qnba
    s_cmp_eq_u32 s51, 1
    s_cbranch_scc0 L_qnba
    s_mov_b64 exec, 0xffff
    buffer_store_dwordx4 v[32:35], v36, s[36:39], s59 offen sc1
    s_mov_b64 exec, -1
    s_mov_b32 s51, 0
L_qnba:
    s_sub_u32 s45, s45, 1
    s_cbranch_scc0 L_qpoll
L_qgo:
    s_waitcnt lgkmcnt(0)
    ds_write_b32 v5, v24 offset:4
    s_mov_b32 s45, 320000
L_lwgv:
    s_sleep 2
    ds_read_b32 v25, v5 offset:120
    s_sub_u32 s45, s45, 1
    s_cbranch_scc1 L_lwdgv
    s_waitcnt lgkmcnt(0)
    v_readfirstlane_b32 s46, v25
    s_cmp_lt_u32 s46, 1
    s_cbranch_scc1 L_lwgv
L_lwdgv:
    s_cmp_eq_u32 s46, 2
    s_cbranch_scc0 L_qnbb
    s_cmp_eq_u32 s51, 1
    s_cbranch_scc0 L_qnbb
    s_mov_b64 exec, 0xffff
    buffer_store_dwordx4 v[32:35], v36, s[36:39], s59 offen sc1
    s_mov_b64 exec, -1
    s_mov_b32 s51, 0
L_qnbb:
    s_endpgm
L_VW:
    s_mov_b64 s[36:37], s[26:27]
    s_mov_b32 s38, 2097152
    s_mov_b32 s39, 0x20000
    s_cmp_ge_u32 s3, 12
    s_cbranch_scc1 L_W
    s_lshl_b32 s46, s30, 3
    s_add_u32 s46, s46, s28
    s_lshl_b32 s47, s46, 21
    s_add_u32 s47, s47, 0x180000
    s_and_b32 s49, s28, 1
    s_lshl_b32 s49, s49, 3
    s_add_u32 s48, s49, s31
    s_lshl_b32 s48, s48, 12
    s_lshl_b32 s49, s49, 15
    s_lshl_b32 s52, s50, 7
    v_lshrrev_b32 v10, 3, v0
    v_lshlrev_b32 v3, 9, v10
    v_and_b32 v11, 7, v0
    v_lshl_add_u32 v3, v11, 4, v3
    v_add_u32 v3, s52, v3
    s_add_u32 s32, s8, s47
    s_addc_u32 s33, s9, 0
    s_mov_b32 s34, 0x80000
    s_mov_b32 s35, 0x20000
    s_mov_b64 exec, 1
    buffer_load_dword v121, v5, s[32:35], 0 offen
    s_mov_b64 exec, -1
    v_lshlrev_b32 v10, 6, v10
    v_and_b32 v12, 1, v0
    v_cmp_eq_u32 vcc, 1, v12
    v_mov_b32 v13, 0xffff
    v_mov_b32 v12, 0xffff0000
    v_cndmask_b32 v13, v13, v12, vcc
    v_bfe_u32 v12, v0, 1, 2
    v_cmp_eq_u32 vcc, 0, v12
    s_nop 1
    v_cndmask_b32 v6, 0, v13, vcc
    v_cmp_eq_u32 vcc, 1, v12
    s_nop 1
    v_cndmask_b32 v7, 0, v13, vcc
    v_cmp_eq_u32 vcc, 2, v12
    s_nop 1
    v_cndmask_b32 v8, 0, v13, vcc
    v_cmp_eq_u32 vcc, 3, v12
    s_nop 1
    v_cndmask_b32 v9, 0, v13, vcc
    s_and_b32 s59, s29, 15
    v_and_b32 v12, 1, v1
    v_cvt_f32_u32 v2, v12
    v_lshl_add_u32 v12, v12, 3, v11
    v_xor_b32 v12, s59, v12
    v_lshrrev_b32 v4, 1, v1
    v_lshlrev_b32 v4, 15, v4
    v_lshl_add_u32 v4, v12, 4, v4
    v_lshlrev_b32 v1, 4, v1
    s_lshl_b32 s58, s28, 16
    s_lshl_b32 s59, s50, 13
    s_add_u32 s58, s58, s59
    s_lshl_b32 s59, s29, 8
    s_add_u32 s58, s58, s59
    s_add_u32 s58, s58, 1572864
    s_lshl_b32 s57, s50, 2
    v_mov_b32 v11, s57
    v_mov_b32 v12, 1
    s_mov_b32 s57, 0
    s_mov_b32 s86, 0
    s_mov_b32 s60, 0x00ff00ff
    s_mov_b32 s61, 0x00ff00ff
    v_mov_b32 v16, 0
    v_mov_b32 v17, 0
    v_mov_b32 v18, 0
    v_mov_b32 v19, 0
    s_mov_b64 exec, s[60:61]
    buffer_store_dwordx4 v[16:19], v4, s[36:39], s58 offen
    s_mov_b64 exec, -1
    s_and_b32 s54, s49, 0x7ffff
    s_and_b32 s46, s48, 0x7fff
    s_or_b32 s54, s54, s46
L_cw0:
    s_cmp_ge_u32 s57, 1
    s_cbranch_scc1 L_cwd0
    s_sleep 1
    ds_read_b32 v14, v11 offset:48
    s_waitcnt lgkmcnt(0)
    v_readfirstlane_b32 s57, v14
    s_branch L_cw0
L_cwd0:
    buffer_load_dwordx4 v[64:67], v3, s[32:35], s54 offen nt
    s_add_u32 s49, s49, 32768
    s_add_u32 s48, s48, 4096
    s_and_b32 s54, s49, 0x7ffff
    s_and_b32 s46, s48, 0x7fff
    s_or_b32 s54, s54, s46
L_cw1:
    s_cmp_ge_u32 s57, 2
    s_cbranch_scc1 L_cwd1
    ds_read_b32 v14, v11 offset:48
    s_waitcnt lgkmcnt(0)
    v_readfirstlane_b32 s57, v14
    s_branch L_cw1
L_cwd1:
    buffer_load_dwordx4 v[68:71], v3, s[32:35], s54 offen nt
    s_add_u32 s49, s49, 32768
    s_add_u32 s48, s48, 4096
    s_and_b32 s54, s49, 0x7ffff
    s_and_b32 s46, s48, 0x7fff
    s_or_b32 s54, s54, s46
L_cw2:
    s_cmp_ge_u32 s57, 3
    s_cbranch_scc1 L_cwd2
    ds_read_b32 v14, v11 offset:48
    s_waitcnt lgkmcnt(0)
    v_readfirstlane_b32 s57, v14
    s_branch L_cw2
L_cwd2:
    buffer_load_dwordx4 v[72:75], v3, s[32:35], s54 offen nt
    s_add_u32 s49, s49, 32768
    s_add_u32 s48, s48, 4096
    s_and_b32 s54, s49, 0x7ffff
    s_and_b32 s46, s48, 0x7fff
    s_or_b32 s54, s54, s46
L_cw3:
    s_cmp_ge_u32 s57, 4
    s_cbranch_scc1 L_cwd3
    ds_read_b32 v14, v11 offset:48
    s_waitcnt lgkmcnt(0)
    v_readfirstlane_b32 s57, v14
    s_branch L_cw3
L_cwd3:
    buffer_load_dwordx4 v[76:79], v3, s[32:35], s54 offen nt
    s_add_u32 s49, s49, 32768
    s_add_u32 s48, s48, 4096
    s_and_b32 s54, s49, 0x7ffff
    s_and_b32 s46, s48, 0x7fff
    s_or_b32 s54, s54, s46
L_cw4:
    s_cmp_ge_u32 s57, 5
    s_cbranch_scc1 L_cwd4
    ds_read_b32 v14, v11 offset:48
    s_waitcnt lgkmcnt(0)
    v_readfirstlane_b32 s57, v14
    s_branch L_cw4
L_cwd4:
    buffer_load_dwordx4 v[80:83], v3, s[32:35], s54 offen nt
    s_add_u32 s49, s49, 32768
    s_add_u32 s48, s48, 4096
    s_and_b32 s54, s49, 0x7ffff
    s_and_b32 s46, s48, 0x7fff
    s_or_b32 s54, s54, s46
L_cw5:
    s_cmp_ge_u32 s57, 6
    s_cbranch_scc1 L_cwd5
    ds_read_b32 v14, v11 offset:48
    s_waitcnt lgkmcnt(0)
    v_readfirstlane_b32 s57, v14
    s_branch L_cw5
L_cwd5:
    buffer_load_dwordx4 v[84:87], v3, s[32:35], s54 offen nt
    s_add_u32 s49, s49, 32768
    s_add_u32 s48, s48, 4096
    s_and_b32 s54, s49, 0x7ffff
    s_and_b32 s46, s48, 0x7fff
    s_or_b32 s54, s54, s46
    s_cmp_lg_u32 s86, 0
    s_cbranch_scc1 L_un6
    ds_read_b32 v14, v5 offset:4
    s_waitcnt vmcnt(5) lgkmcnt(0)
    v_readfirstlane_b32 s86, v14
L_un6:
    buffer_load_dwordx4 v[88:91], v3, s[32:35], s54 offen nt
    s_add_u32 s49, s49, 32768
    s_add_u32 s48, s48, 4096
    s_and_b32 s54, s49, 0x7ffff
    s_and_b32 s46, s48, 0x7fff
    s_or_b32 s54, s54, s46
    s_cmp_lg_u32 s86, 0
    s_cbranch_scc1 L_un7
    ds_read_b32 v14, v5 offset:4
    s_waitcnt vmcnt(5) lgkmcnt(0)
    v_readfirstlane_b32 s86, v14
L_un7:
    buffer_load_dwordx4 v[92:95], v3, s[32:35], s54 offen nt
    s_add_u32 s49, s49, 32768
    s_add_u32 s48, s48, 4096
    s_and_b32 s54, s49, 0x7ffff
    s_and_b32 s46, s48, 0x7fff
    s_or_b32 s54, s54, s46
    s_cmp_lg_u32 s86, 0
    s_cbranch_scc1 L_un8
    ds_read_b32 v14, v5 offset:4
    s_waitcnt vmcnt(5) lgkmcnt(0)
    v_readfirstlane_b32 s86, v14
L_un8:
    buffer_load_dwordx4 v[96:99], v3, s[32:35], s54 offen nt
    s_add_u32 s49, s49, 32768
    s_add_u32 s48, s48, 4096
    s_and_b32 s54, s49, 0x7ffff
    s_and_b32 s46, s48, 0x7fff
    s_or_b32 s54, s54, s46
    s_cmp_lg_u32 s86, 0
    s_cbranch_scc1 L_un9
    ds_read_b32 v14, v5 offset:4
    s_waitcnt vmcnt(5) lgkmcnt(0)
    v_readfirstlane_b32 s86, v14
L_un9:
    buffer_load_dwordx4 v[100:103], v3, s[32:35], s54 offen nt
    s_add_u32 s49, s49, 32768
    s_add_u32 s48, s48, 4096
    s_and_b32 s54, s49, 0x7ffff
    s_and_b32 s46, s48, 0x7fff
    s_or_b32 s54, s54, s46
    s_cmp_lg_u32 s86, 0
    s_cbranch_scc1 L_un10
    ds_read_b32 v14, v5 offset:4
    s_waitcnt vmcnt(5) lgkmcnt(0)
    v_readfirstlane_b32 s86, v14
L_un10:
    buffer_load_dwordx4 v[104:107], v3, s[32:35], s54 offen nt
    s_add_u32 s49, s49, 32768
    s_add_u32 s48, s48, 4096
    s_and_b32 s54, s49, 0x7ffff
    s_and_b32 s46, s48, 0x7fff
    s_or_b32 s54, s54, s46
    s_cmp_lg_u32 s86, 0
    s_cbranch_scc1 L_un11
    ds_read_b32 v14, v5 offset:4
    s_waitcnt vmcnt(5) lgkmcnt(0)
    v_readfirstlane_b32 s86, v14
L_un11:
    buffer_load_dwordx4 v[108:111], v3, s[32:35], s54 offen nt
    s_add_u32 s49, s49, 32768
    s_add_u32 s48, s48, 4096
    s_and_b32 s54, s49, 0x7ffff
    s_and_b32 s46, s48, 0x7fff
    s_or_b32 s54, s54, s46
    s_cmp_lg_u32 s86, 0
    s_cbranch_scc1 L_un12
    ds_read_b32 v14, v5 offset:4
    s_waitcnt vmcnt(5) lgkmcnt(0)
    v_readfirstlane_b32 s86, v14
L_un12:
    buffer_load_dwordx4 v[112:115], v3, s[32:35], s54 offen nt
    s_add_u32 s49, s49, 32768
    s_add_u32 s48, s48, 4096
    s_and_b32 s54, s49, 0x7ffff
    s_and_b32 s46, s48, 0x7fff
    s_or_b32 s54, s54, s46
    s_cmp_lg_u32 s86, 0
    s_cbranch_scc1 L_un13
    ds_read_b32 v14, v5 offset:4
    s_waitcnt vmcnt(5) lgkmcnt(0)
    v_readfirstlane_b32 s86, v14
L_un13:
    buffer_load_dwordx4 v[116:119], v3, s[32:35], s54 offen nt
    s_add_u32 s49, s49, 32768
    s_add_u32 s48, s48, 4096
    s_and_b32 s54, s49, 0x7ffff
    s_and_b32 s46, s48, 0x7fff
    s_or_b32 s54, s54, s46
    s_cmp_lg_u32 s86, 0
    s_cbranch_scc1 L_un14
    ds_read_b32 v14, v5 offset:4
    s_waitcnt vmcnt(5) lgkmcnt(0)
    v_readfirstlane_b32 s86, v14
L_un14:
    buffer_load_dwordx4 v[120:123], v3, s[32:35], s54 offen nt
    s_add_u32 s49, s49, 32768
    s_add_u32 s48, s48, 4096
    s_and_b32 s54, s49, 0x7ffff
    s_and_b32 s46, s48, 0x7fff
    s_or_b32 s54, s54, s46
    s_cmp_lg_u32 s86, 0
    s_cbranch_scc1 L_un15
    ds_read_b32 v14, v5 offset:4
    s_waitcnt vmcnt(5) lgkmcnt(0)
    v_readfirstlane_b32 s86, v14
L_un15:
    buffer_load_dwordx4 v[124:127], v3, s[32:35], s54 offen nt
    ds_write_b32 v11, v12 offset:32
    s_mov_b32 s45, 320000
L_l4v:
    ds_read_b128 v[12:15], v5 offset:16
    s_sub_u32 s45, s45, 1
    s_cbranch_scc1 L_l4dv
    s_waitcnt lgkmcnt(0)
    v_and_b32 v12, v12, v13
    v_and_b32 v14, v14, v15
    v_and_b32 v12, v12, v14
    v_cmp_eq_u32 vcc, 0, v12
    s_cbranch_vccnz L_l4v
L_l4dv:
    ds_read_b128 v[16:19], v10 offset:256
    ds_read_b128 v[20:23], v10 offset:272
    ds_read_b128 v[24:27], v10 offset:288
    ds_read_b128 v[28:31], v10 offset:304
    ds_read_b128 v[32:35], v10 offset:768
    ds_read_b128 v[36:39], v10 offset:784
    ds_read_b128 v[40:43], v10 offset:800
    ds_read_b128 v[44:47], v10 offset:816
    ds_read_b128 v[48:51], v1 offset:128
    ds_read_b32 v15, v5 offset:0
    s_waitcnt lgkmcnt(0)
    v_add_f32 v49, v49, v50
    v_add_f32 v49, v49, v51
    v_fma_f32 v14, v49, v2, v48
    v_and_b32 v48, v16, v6
    v_and_b32 v49, v16, v7
    v_and_b32 v50, v16, v8
    v_and_b32 v51, v16, v9
    v_and_b32 v52, v32, v6
    v_and_b32 v53, v32, v7
    v_and_b32 v54, v32, v8
    v_and_b32 v55, v32, v9
    s_nop 0
    s_waitcnt vmcnt(15)
    v_mfma_f32_16x16x32_bf16 v[56:59], v[48:51], v[64:67], 0
    v_mfma_f32_16x16x32_bf16 v[60:63], v[52:55], v[64:67], 0
    v_and_b32 v48, v24, v6
    v_and_b32 v49, v24, v7
    v_and_b32 v50, v24, v8
    v_and_b32 v51, v24, v9
    v_and_b32 v52, v40, v6
    v_and_b32 v53, v40, v7
    v_and_b32 v54, v40, v8
    v_and_b32 v55, v40, v9
    s_nop 0
    s_waitcnt vmcnt(14)
    v_mfma_f32_16x16x32_bf16 v[56:59], v[48:51], v[68:71], v[56:59]
    v_mfma_f32_16x16x32_bf16 v[60:63], v[52:55], v[68:71], v[60:63]
    v_and_b32 v48, v17, v6
    v_and_b32 v49, v17, v7
    v_and_b32 v50, v17, v8
    v_and_b32 v51, v17, v9
    v_and_b32 v52, v33, v6
    v_and_b32 v53, v33, v7
    v_and_b32 v54, v33, v8
    v_and_b32 v55, v33, v9
    s_nop 0
    s_waitcnt vmcnt(13)
    v_mfma_f32_16x16x32_bf16 v[56:59], v[48:51], v[72:75], v[56:59]
    v_mfma_f32_16x16x32_bf16 v[60:63], v[52:55], v[72:75], v[60:63]
    v_and_b32 v48, v25, v6
    v_and_b32 v49, v25, v7
    v_and_b32 v50, v25, v8
    v_and_b32 v51, v25, v9
    v_and_b32 v52, v41, v6
    v_and_b32 v53, v41, v7
    v_and_b32 v54, v41, v8
    v_and_b32 v55, v41, v9
    s_nop 0
    s_waitcnt vmcnt(12)
    v_mfma_f32_16x16x32_bf16 v[56:59], v[48:51], v[76:79], v[56:59]
    v_mfma_f32_16x16x32_bf16 v[60:63], v[52:55], v[76:79], v[60:63]
    v_and_b32 v48, v18, v6
    v_and_b32 v49, v18, v7
    v_and_b32 v50, v18, v8
    v_and_b32 v51, v18, v9
    v_and_b32 v52, v34, v6
    v_and_b32 v53, v34, v7
    v_and_b32 v54, v34, v8
    v_and_b32 v55, v34, v9
    s_nop 0
    s_waitcnt vmcnt(11)
    v_mfma_f32_16x16x32_bf16 v[56:59], v[48:51], v[80:83], v[56:59]
    v_mfma_f32_16x16x32_bf16 v[60:63], v[52:55], v[80:83], v[60:63]
    v_and_b32 v48, v26, v6
    v_and_b32 v49, v26, v7
    v_and_b32 v50, v26, v8
    v_and_b32 v51, v26, v9
    v_and_b32 v52, v42, v6
    v_and_b32 v53, v42, v7
    v_and_b32 v54, v42, v8
    v_and_b32 v55, v42, v9
    s_nop 0
    s_waitcnt vmcnt(10)
    v_mfma_f32_16x16x32_bf16 v[56:59], v[48:51], v[84:87], v[56:59]
    v_mfma_f32_16x16x32_bf16 v[60:63], v[52:55], v[84:87], v[60:63]
    v_and_b32 v48, v19, v6
    v_and_b32 v49, v19, v7
    v_and_b32 v50, v19, v8
    v_and_b32 v51, v19, v9
    v_and_b32 v52, v35, v6
    v_and_b32 v53, v35, v7
    v_and_b32 v54, v35, v8
    v_and_b32 v55, v35, v9
    s_nop 0
    s_waitcnt vmcnt(9)
    v_mfma_f32_16x16x32_bf16 v[56:59], v[48:51], v[88:91], v[56:59]
    v_mfma_f32_16x16x32_bf16 v[60:63], v[52:55], v[88:91], v[60:63]
    v_and_b32 v48, v27, v6
    v_and_b32 v49, v27, v7
    v_and_b32 v50, v27, v8
    v_and_b32 v51, v27, v9
    v_and_b32 v52, v43, v6
    v_and_b32 v53, v43, v7
    v_and_b32 v54, v43, v8
    v_and_b32 v55, v43, v9
    s_nop 0
    s_waitcnt vmcnt(8)
    v_mfma_f32_16x16x32_bf16 v[56:59], v[48:51], v[92:95], v[56:59]
    v_mfma_f32_16x16x32_bf16 v[60:63], v[52:55], v[92:95], v[60:63]
    v_and_b32 v48, v20, v6
    v_and_b32 v49, v20, v7
    v_and_b32 v50, v20, v8
    v_and_b32 v51, v20, v9
    v_and_b32 v52, v36, v6
    v_and_b32 v53, v36, v7
    v_and_b32 v54, v36, v8
    v_and_b32 v55, v36, v9
    s_nop 0
    s_waitcnt vmcnt(7)
    v_mfma_f32_16x16x32_bf16 v[56:59], v[48:51], v[96:99], v[56:59]
    v_mfma_f32_16x16x32_bf16 v[60:63], v[52:55], v[96:99], v[60:63]
    v_and_b32 v48, v28, v6
    v_and_b32 v49, v28, v7
    v_and_b32 v50, v28, v8
    v_and_b32 v51, v28, v9
    v_and_b32 v52, v44, v6
    v_and_b32 v53, v44, v7
    v_and_b32 v54, v44, v8
    v_and_b32 v55, v44, v9
    s_nop 0
    s_waitcnt vmcnt(6)
    v_mfma_f32_16x16x32_bf16 v[56:59], v[48:51], v[100:103], v[56:59]
    v_mfma_f32_16x16x32_bf16 v[60:63], v[52:55], v[100:103], v[60:63]
    v_and_b32 v48, v21, v6
    v_and_b32 v49, v21, v7
    v_and_b32 v50, v21, v8
    v_and_b32 v51, v21, v9
    v_and_b32 v52, v37, v6
    v_and_b32 v53, v37, v7
    v_and_b32 v54, v37, v8
    v_and_b32 v55, v37, v9
    s_nop 0
    s_waitcnt vmcnt(5)
    v_mfma_f32_16x16x32_bf16 v[56:59], v[48:51], v[104:107], v[56:59]
    v_mfma_f32_16x16x32_bf16 v[60:63], v[52:55], v[104:107], v[60:63]
    v_and_b32 v48, v29, v6
    v_and_b32 v49, v29, v7
    v_and_b32 v50, v29, v8
    v_and_b32 v51, v29, v9
    v_and_b32 v52, v45, v6
    v_and_b32 v53, v45, v7
    v_and_b32 v54, v45, v8
    v_and_b32 v55, v45, v9
    s_nop 0
    s_waitcnt vmcnt(4)
    v_mfma_f32_16x16x32_bf16 v[56:59], v[48:51], v[108:111], v[56:59]
    v_mfma_f32_16x16x32_bf16 v[60:63], v[52:55], v[108:111], v[60:63]
    v_and_b32 v48, v22, v6
    v_and_b32 v49, v22, v7
    v_and_b32 v50, v22, v8
    v_and_b32 v51, v22, v9
    v_and_b32 v52, v38, v6
    v_and_b32 v53, v38, v7
    v_and_b32 v54, v38, v8
    v_and_b32 v55, v38, v9
    s_nop 0
    s_waitcnt vmcnt(3)
    v_mfma_f32_16x16x32_bf16 v[56:59], v[48:51], v[112:115], v[56:59]
    v_mfma_f32_16x16x32_bf16 v[60:63], v[52:55], v[112:115], v[60:63]
    v_and_b32 v48, v30, v6
    v_and_b32 v49, v30, v7
    v_and_b32 v50, v30, v8
    v_and_b32 v51, v30, v9
    v_and_b32 v52, v46, v6
    v_and_b32 v53, v46, v7
    v_and_b32 v54, v46, v8
    v_and_b32 v55, v46, v9
    s_nop 0
    s_waitcnt vmcnt(2)
    v_mfma_f32_16x16x32_bf16 v[56:59], v[48:51], v[116:119], v[56:59]
    v_mfma_f32_16x16x32_bf16 v[60:63], v[52:55], v[116:119], v[60:63]
    v_and_b32 v48, v23, v6
    v_and_b32 v49, v23, v7
    v_and_b32 v50, v23, v8
    v_and_b32 v51, v23, v9
    v_and_b32 v52, v39, v6
    v_and_b32 v53, v39, v7
    v_and_b32 v54, v39, v8
    v_and_b32 v55, v39, v9
    s_nop 0
    s_waitcnt vmcnt(1)
    v_mfma_f32_16x16x32_bf16 v[56:59], v[48:51], v[120:123], v[56:59]
    v_mfma_f32_16x16x32_bf16 v[60:63], v[52:55], v[120:123], v[60:63]
    v_and_b32 v48, v31, v6
    v_and_b32 v49, v31, v7
    v_and_b32 v50, v31, v8
    v_and_b32 v51, v31, v9
    v_and_b32 v52, v47, v6
    v_and_b32 v53, v47, v7
    v_and_b32 v54, v47, v8
    v_and_b32 v55, v47, v9
    s_nop 0
    s_waitcnt vmcnt(0)
    v_mfma_f32_16x16x32_bf16 v[56:59], v[48:51], v[124:127], v[56:59]
    v_mfma_f32_16x16x32_bf16 v[60:63], v[52:55], v[124:127], v[60:63]
    v_mov_b32 v16, 1
    s_nop 6
    v_permlane32_swap_b32 v56, v60
    v_permlane32_swap_b32 v57, v61
    v_permlane32_swap_b32 v58, v62
    v_permlane32_swap_b32 v59, v63
    v_add_f32_dpp v56, v60, v56 row_ror:8 row_mask:0xf bank_mask:0xf
    v_add_f32_dpp v57, v61, v57 row_ror:8 row_mask:0xf bank_mask:0xf
    v_add_f32_dpp v58, v62, v58 row_ror:8 row_mask:0xf bank_mask:0xf
    v_add_f32_dpp v59, v63, v59 row_ror:8 row_mask:0xf bank_mask:0xf
    s_mov_b64 exec, s[60:61]
    v_cvt_pk_bf16_f32 v12, v56, v57
    v_cvt_pk_bf16_f32 v13, v58, v59
    buffer_store_dwordx4 v[12:15], v4, s[36:39], s58 offen
    s_mov_b64 exec, 1
    ds_add_u32 v5, v16 offset:116
    s_mov_b64 exec, s[60:61]
    s_mov_b32 s45, 320000
L_lwvv:
    s_sleep 1
    ds_read_b32 v17, v5 offset:120
    s_sub_u32 s45, s45, 1
    s_cbranch_scc1 L_lwdvv
    s_waitcnt lgkmcnt(0)
    v_readfirstlane_b32 s46, v17
    s_cmp_lt_u32 s46, 1
    s_cbranch_scc1 L_lwvv
L_lwdvv:
    s_cmp_eq_u32 s46, 1
    s_cbranch_scc1 L_end
    buffer_store_dwordx4 v[12:15], v4, s[36:39], s58 offen sc1
    s_endpgm
L_W:
    s_cmp_ge_u32 s29, 28
    s_cbranch_scc1 L_end
    s_lshr_b32 s47, s29, 2
    s_and_b32 s49, s29, 1
    s_bfe_u32 s46, s29, 0x10001
    s_lshl_b32 s85, s28, 1
    s_add_u32 s85, s85, s46
    s_lshl_b32 s51, s85, 2
    s_add_u32 s51, s51, s50
    s_lshr_b32 s55, s51, 1
    s_and_b32 s48, s51, 1
    s_mul_i32 s84, s50, 0x3000
    s_add_u32 s84, s84, 37888
    s_mov_b64 s[32:33], s[12:13]
    s_mov_b32 s34, 3670016
    s_mov_b32 s35, 0x20000
    s_mov_b64 s[80:81], s[20:21]
    s_mov_b32 s82, 1605632
    s_mov_b32 s83, 0x20000
    s_mul_i32 s62, s51, 57344
    s_mul_i32 s63, s51, 28672
    s_lshl_b32 s57, s47, 7
    s_add_u32 s62, s62, s57
    s_add_u32 s63, s63, s57
    s_mov_b64 exec, 1
    buffer_load_dword v121, v5, s[32:35], s62 offen
    buffer_load_dword v122, v5, s[80:83], s63 offen
    s_mov_b64 exec, -1
    v_lshrrev_b32 v6, 3, v0
    v_mul_u32_u24 v6, 896, v6
    v_and_b32 v40, 7, v0
    v_bfe_u32 v41, v0, 4, 1
    v_lshlrev_b32 v41, 1, v41
    v_xor_b32 v40, v40, v41
    v_xor_b32 v41, 4, v40
    v_lshl_add_u32 v40, v40, 4, v6
    v_lshl_add_u32 v41, v41, 4, v6
    v_lshlrev_b32 v10, 10, v1
    v_lshrrev_b32 v11, 2, v2
    v_lshl_add_u32 v10, v11, 7, v10
    v_and_b32 v11, 3, v0
    v_lshl_add_u32 v10, v11, 3, v10
    v_add_u32 v10, s84, v10
    v_bfe_u32 v11, v0, 3, 2
    v_xor_b32 v12, 0, v11
    v_lshl_add_u32 v6, v12, 5, v10
    v_xor_b32 v12, 1, v11
    v_lshl_add_u32 v7, v12, 5, v10
    v_xor_b32 v12, 2, v11
    v_lshl_add_u32 v8, v12, 5, v10
    v_xor_b32 v12, 3, v11
    v_lshl_add_u32 v9, v12, 5, v10
    v_and_b32 v10, 1, v0
    v_lshlrev_b32 v10, 10, v10
    v_bfe_u32 v11, v0, 3, 1
    v_lshl_add_u32 v10, v11, 6, v10
    v_lshrrev_b32 v11, 1, v1
    v_lshl_add_u32 v10, v11, 8, v10
    v_and_b32 v11, 1, v1
    v_lshl_add_u32 v10, v11, 5, v10
    v_lshlrev_b32 v14, 4, v1
    v_bfe_u32 v11, v0, 2, 1
    v_lshl_add_u32 v10, v11, 4, v10
    v_lshl_add_u32 v14, v11, 3, v14
    s_lshl_b32 s53, s55, 11
    s_lshl_b32 s54, s48, 9
    s_add_u32 s53, s53, s54
    s_lshl_b32 s54, s49, 7
    s_add_u32 s53, s53, s54
    s_add_u32 s53, s53, 135168
    s_mov_b64 s[40:41], s[18:19]
    s_mov_b32 s42, 3584
    s_mov_b32 s43, 0x20000
    s_lshl_b32 s54, s51, 6
    buffer_load_dwordx2 v[20:21], v14, s[40:43], s54 offen
    s_lshl_b32 s54, s51, 13
    s_lshl_b32 s58, s49, 12
    s_add_u32 s54, s54, s58
    s_add_u32 s54, s54, 1572864
    v_lshlrev_b32 v11, 4, v0
    s_lshl_b32 s56, s47, 1
    s_add_u32 s56, s56, s49
    s_lshl_b32 s88, s56, 2
    s_add_u32 s88, s88, s50
    s_lshl_b32 s56, s88, 9
    s_add_u32 s56, s56, 262144
    s_lshl_b32 s88, s88, 7
    s_add_u32 s88, s88, 327680
    v_lshlrev_b32 v13, 3, v0
    s_lshl_b32 s58, s50, 9
    v_add_u32 v12, s58, v13
    v_lshrrev_b32 v113, 3, v0
    s_lshl_b32 s58, s50, 3
    v_add_u32 v113, s58, v113
    v_mul_u32_u24 v113, 7, v113
    v_and_b32 v114, 7, v0
    v_add_u32 v113, v113, v114
    v_cmp_gt_u32 vcc, 128, v113
    v_cmp_gt_u32 s[90:91], 7, v114
    v_cmp_eq_u32 s[92:93], 7, v114
    s_and_b64 s[90:91], s[90:91], vcc
    v_min_u32 v113, 127, v113
    v_cndmask_b32 v115, 0, 1.0, s[92:93]
    v_and_b32 v116, 1, v113
    v_lshlrev_b32 v117, 6, v116
    v_bfe_u32 v116, v113, 1, 4
    v_lshl_add_u32 v117, v116, 1, v117
    v_bfe_u32 v116, v113, 5, 1
    v_lshl_add_u32 v117, v116, 5, v117
    v_lshrrev_b32 v116, 6, v113
    v_mul_u32_u24 v116, 896, v116
    v_add_u32 v117, v117, v116
    s_mul_i32 s89, s49, 1792
    s_lshl_b32 s58, s47, 7
    s_add_u32 s89, s89, s58
    v_lshlrev_b32 v113, 2, v113
    v_add_u32 v113, 5120, v113
    s_cmp_eq_u32 s50, 2
    s_cselect_b32 s94, 0xffffff, -1
    s_cselect_b32 s95, 0, -1
    s_lshl_b32 s58, s50, 12
    s_add_u32 s58, s58, 87040
    v_xor_b32 v4, v1, v2
    v_lshlrev_b32 v14, 8, v2
    v_add_u32 v14, s58, v14
    v_xor_b32 v42, 0, v4
    v_lshl_add_u32 v44, v42, 4, v14
    v_xor_b32 v42, 8, v4
    v_lshl_add_u32 v45, v42, 4, v14
    v_xor_b32 v42, 4, v4
    v_lshl_add_u32 v46, v42, 4, v14
    v_xor_b32 v42, 12, v4
    v_lshl_add_u32 v47, v42, 4, v14
    s_lshl_b32 s57, s50, 2
    v_mov_b32 v43, s57
    s_add_u32 m0, s84, 8192
    s_mov_b32 s45, 320000
L_lww:
    s_sleep 2
    ds_read_b32 v14, v5 offset:0
    s_sub_u32 s45, s45, 1
    s_cbranch_scc1 L_lwdw
    s_waitcnt lgkmcnt(0)
    v_readfirstlane_b32 s44, v14
    s_cmp_lt_u32 s44, 1
    s_cbranch_scc1 L_lww
L_lwdw:
    v_mov_b32 v48, 0
    v_mov_b32 v52, 0
    v_mov_b32 v56, 0
    v_mov_b32 v60, 0
    s_mov_b64 s[40:41], s[4:5]
    s_cmp_lg_u32 s85, 0
    s_cbranch_scc1 L_noini
    s_cmp_eq_u32 s50, 3
    s_cbranch_scc1 L_noini
    buffer_load_ushort v24, v117, s[40:43], s89 offen
    v_mov_b32 v28, s44
    v_mov_b32 v29, s44
    v_mov_b32 v30, s44
    v_mov_b32 v31, s44
    s_waitcnt vmcnt(0)
    v_lshlrev_b32 v24, 16, v24
    v_cndmask_b32 v24, 0, v24, s[90:91]
    v_cvt_f64_f32 v[26:27], v24
    buffer_store_dwordx2 v[26:27], v13, s[36:39], s56 offen sc1
    s_waitcnt vmcnt(0)
    s_mov_b64 exec, 0xff
    buffer_store_dwordx4 v[28:31], v11, s[36:39], s88 offen sc1
    s_mov_b64 exec, -1
L_noini:
    s_mov_b64 s[40:41], s[22:23]
    s_mov_b32 s45, 320000
L_lwhq:
    s_sleep 2
    ds_read_b32 v14, v5 offset:4
    s_sub_u32 s45, s45, 1
    s_cbranch_scc1 L_lwdhq
    s_waitcnt lgkmcnt(0)
    v_readfirstlane_b32 s52, v14
    s_cmp_lt_u32 s52, 1
    s_cbranch_scc1 L_lwhq
L_lwdhq:
    buffer_load_dword v118, v5, s[36:39], s88 offen sc1
    buffer_load_dwordx4 v[16:19], v10, s[36:39], s53 offen sc1
    buffer_load_dwordx4 v40, s[80:83], s63 offen offset:0 lds
    s_add_u32 s63, s63, 6144
    buffer_load_dwordx4 v41, s[80:83], s63 offen offset:1024 lds
    s_add_u32 s63, s63, 6144
    buffer_load_dwordx4 v40, s[80:83], s63 offen offset:2048 lds
    s_add_u32 s63, s63, 6144
    buffer_load_dwordx4 v41, s[80:83], s63 offen offset:3072 lds
    s_mov_b32 m0, s84
    s_mov_b32 s45, 320000
L_lwc:
    s_sleep 1
    ds_read_b32 v14, v43 offset:32
    s_sub_u32 s45, s45, 1
    s_cbranch_scc1 L_lwdc
    s_waitcnt lgkmcnt(0)
    v_readfirstlane_b32 s52, v14
    s_cmp_lt_u32 s52, 1
    s_cbranch_scc1 L_lwc
L_lwdc:
    buffer_load_dwordx4 v40, s[32:35], s62 offen offset:0 lds
    s_add_u32 s62, s62, 6144
    buffer_load_dwordx4 v41, s[32:35], s62 offen offset:1024 lds
    s_add_u32 s62, s62, 6144
    buffer_load_dwordx4 v40, s[32:35], s62 offen offset:2048 lds
    s_add_u32 s62, s62, 6144
    buffer_load_dwordx4 v41, s[32:35], s62 offen offset:3072 lds
    s_add_u32 m0, s84, 4096
    s_add_u32 s62, s62, 10240
    buffer_load_dwordx4 v40, s[32:35], s62 offen offset:0 lds
    s_add_u32 s62, s62, 6144
    buffer_load_dwordx4 v41, s[32:35], s62 offen offset:1024 lds
    s_add_u32 s62, s62, 6144
    buffer_load_dwordx4 v40, s[32:35], s62 offen offset:2048 lds
    s_add_u32 s62, s62, 6144
    buffer_load_dwordx4 v41, s[32:35], s62 offen offset:3072 lds
    s_waitcnt vmcnt(8)
    s_cmp_eq_u32 s28, 7
    s_cbranch_scc1 L_skipm
    s_mov_b32 s45, 40000
    s_branch L_achk
L_apoll:
    buffer_load_dwordx4 v[16:19], v10, s[36:39], s53 offen sc1
    s_sub_u32 s45, s45, 1
    s_waitcnt vmcnt(0)
    s_cbranch_scc1 L_ago
L_achk:
    v_cmp_ne_u32 vcc, s44, v19
    s_cbranch_vccnz L_apoll
L_ago:
    ds_read_b64_tr_b16 v[96:97], v6 offset:8192
    ds_read_b64_tr_b16 v[98:99], v6 offset:8704
    ds_read_b64_tr_b16 v[100:101], v7 offset:8192
    ds_read_b64_tr_b16 v[102:103], v7 offset:8704
    ds_read_b64_tr_b16 v[104:105], v8 offset:8192
    ds_read_b64_tr_b16 v[106:107], v8 offset:8704
    ds_read_b64_tr_b16 v[108:109], v9 offset:8192
    ds_read_b64_tr_b16 v[110:111], v9 offset:8704
    v_lshlrev_b32 v24, 16, v16
    v_and_b32 v25, 0xffff0000, v16
    v_lshlrev_b32 v26, 16, v17
    v_and_b32 v27, 0xffff0000, v17
    v_lshlrev_b32 v28, 16, v20
    v_and_b32 v29, 0xffff0000, v20
    v_lshlrev_b32 v30, 16, v21
    v_and_b32 v31, 0xffff0000, v21
    v_add_f32_dpp v24, v24, v24 quad_perm:[1,0,3,2] row_mask:0xf bank_mask:0xf
    v_add_f32_dpp v25, v25, v25 quad_perm:[1,0,3,2] row_mask:0xf bank_mask:0xf
    v_add_f32_dpp v26, v26, v26 quad_perm:[1,0,3,2] row_mask:0xf bank_mask:0xf
    v_add_f32_dpp v27, v27, v27 quad_perm:[1,0,3,2] row_mask:0xf bank_mask:0xf
    v_add_f32 v24, v24, v28
    v_add_f32 v25, v25, v29
    v_add_f32 v26, v26, v30
    v_add_f32 v27, v27, v31
    v_min_f32 v28, 0x41a00000, v24
    v_min_f32 v29, 0x41a00000, v25
    v_min_f32 v30, 0x41a00000, v26
    v_min_f32 v31, 0x41a00000, v27
    v_mul_f32 v28, 0x3fb8aa3b, v28
    v_mul_f32 v29, 0x3fb8aa3b, v29
    v_mul_f32 v30, 0x3fb8aa3b, v30
    v_mul_f32 v31, 0x3fb8aa3b, v31
    v_exp_f32 v28, v28
    v_exp_f32 v29, v29
    v_exp_f32 v30, v30
    v_exp_f32 v31, v31
    s_nop 0
    v_add_f32 v32, 2.0, v28
    v_add_f32 v33, 2.0, v29
    v_add_f32 v34, 2.0, v30
    v_add_f32 v35, 2.0, v31
    v_mul_f32 v28, v28, v32
    v_mul_f32 v29, v29, v33
    v_mul_f32 v30, v30, v34
    v_mul_f32 v31, v31, v35
    v_add_f32 v32, 2.0, v28
    v_add_f32 v33, 2.0, v29
    v_add_f32 v34, 2.0, v30
    v_add_f32 v35, 2.0, v31
    v_rcp_f32 v32, v32
    v_rcp_f32 v33, v33
    v_rcp_f32 v34, v34
    v_rcp_f32 v35, v35
    s_nop 0
    v_mul_f32 v28, v28, v32
    v_mul_f32 v29, v29, v33
    v_mul_f32 v30, v30, v34
    v_mul_f32 v31, v31, v35
    v_mul_f32 v24, v24, v28
    v_mul_f32 v25, v25, v29
    v_mul_f32 v26, v26, v30
    v_mul_f32 v27, v27, v31
    v_cvt_pk_bf16_f32 v32, v24, v25
    v_cvt_pk_bf16_f32 v33, v26, v27
    s_nop 1
    v_mov_b32_dpp v16, v32 row_newbcast:0 row_mask:0xf bank_mask:0x3
    v_mov_b32_dpp v17, v33 row_newbcast:0 row_mask:0xf bank_mask:0x3
    v_mov_b32_dpp v18, v32 row_newbcast:4 row_mask:0xf bank_mask:0x3
    v_mov_b32_dpp v19, v33 row_newbcast:4 row_mask:0xf bank_mask:0x3
    v_mov_b32_dpp v16, v32 row_newbcast:8 row_mask:0xf bank_mask:0xc
    v_mov_b32_dpp v17, v33 row_newbcast:8 row_mask:0xf bank_mask:0xc
    v_mov_b32_dpp v18, v32 row_newbcast:12 row_mask:0xf bank_mask:0xc
    v_mov_b32_dpp v19, v33 row_newbcast:12 row_mask:0xf bank_mask:0xc
    s_nop 0
    s_waitcnt lgkmcnt(0)
    v_mfma_f32_16x16x32_bf16 v[48:51], v[16:19], v[96:99], 0
    v_mfma_f32_16x16x32_bf16 v[52:55], v[16:19], v[100:103], 0
    v_mfma_f32_16x16x32_bf16 v[56:59], v[16:19], v[104:107], 0
    v_mfma_f32_16x16x32_bf16 v[60:63], v[16:19], v[108:111], 0
L_skipm:
    s_cmp_eq_u32 s50, 3
    s_cbranch_scc1 L_ifok
    s_mov_b32 s45, 40000
L_ifp:
    v_cmp_ne_u32 vcc, s44, v118
    s_cbranch_vccz L_ifok
    buffer_load_dword v118, v5, s[36:39], s88 offen sc1
    s_sub_u32 s45, s45, 1
    s_waitcnt vmcnt(0)
    s_cbranch_scc0 L_ifp
L_ifok:
    s_nop 7
    v_mul_f32 v36, 0.5, v48
    v_mul_f32 v37, 0.5, v52
    v_mul_f32 v38, 0.5, v56
    v_mul_f32 v39, 0.5, v60
    s_mov_b32 m0, s58
    v_mov_b32 v42, 1
    v_mov_b32 v34, s44
    s_mov_b32 s45, 320000
L_lwwvp:
    ds_read_b32 v14, v5 offset:116
    s_sub_u32 s45, s45, 1
    s_cbranch_scc1 L_lwdwvp
    s_waitcnt lgkmcnt(0)
    v_readfirstlane_b32 s52, v14
    s_cmp_lt_u32 s52, 4
    s_cbranch_scc1 L_lwwvp
L_lwdwvp:
    s_mov_b32 s45, 40000
    buffer_load_dwordx4 v11, s[36:39], s54 offen offset:0 sc1 lds
    buffer_load_dwordx4 v11, s[36:39], s54 offen offset:1024 sc1 lds
    buffer_load_dwordx4 v11, s[36:39], s54 offen offset:2048 sc1 lds
    buffer_load_dwordx4 v11, s[36:39], s54 offen offset:3072 sc1 lds
    s_waitcnt vmcnt(8)
    ds_read_b64_tr_b16 v[64:65], v6 offset:0
    ds_read_b64_tr_b16 v[66:67], v6 offset:512
    ds_read_b64_tr_b16 v[72:73], v7 offset:0
    ds_read_b64_tr_b16 v[74:75], v7 offset:512
    ds_read_b64_tr_b16 v[80:81], v8 offset:0
    ds_read_b64_tr_b16 v[82:83], v8 offset:512
    ds_read_b64_tr_b16 v[88:89], v9 offset:0
    ds_read_b64_tr_b16 v[90:91], v9 offset:512
    s_waitcnt lgkmcnt(0)
    s_waitcnt vmcnt(4)
    ds_read_b64_tr_b16 v[68:69], v6 offset:4096
    ds_read_b64_tr_b16 v[70:71], v6 offset:4608
    ds_read_b64_tr_b16 v[76:77], v7 offset:4096
    ds_read_b64_tr_b16 v[78:79], v7 offset:4608
    ds_read_b64_tr_b16 v[84:85], v8 offset:4096
    ds_read_b64_tr_b16 v[86:87], v8 offset:4608
    ds_read_b64_tr_b16 v[92:93], v9 offset:4096
    ds_read_b64_tr_b16 v[94:95], v9 offset:4608
    s_branch L_ochk
L_opoll:
    s_or_b32 s52, vcc_lo, vcc_hi
    s_lshr_b32 s53, s52, 16
    s_or_b32 s52, s52, s53
    s_and_b32 s53, s52, 0xf
    s_cbranch_scc0 L_os0
    buffer_load_dwordx4 v11, s[36:39], s54 offen offset:0 sc1 lds
L_os0:
    s_and_b32 s53, s52, 0xf0
    s_cbranch_scc0 L_os1
    buffer_load_dwordx4 v11, s[36:39], s54 offen offset:1024 sc1 lds
L_os1:
    s_and_b32 s53, s52, 0xf00
    s_cbranch_scc0 L_os2
    buffer_load_dwordx4 v11, s[36:39], s54 offen offset:2048 sc1 lds
L_os2:
    s_and_b32 s53, s52, 0xf000
    s_cbranch_scc0 L_os3
    buffer_load_dwordx4 v11, s[36:39], s54 offen offset:3072 sc1 lds
L_os3:
L_ochk:
    s_waitcnt vmcnt(0)
    ds_read_b128 v[16:19], v44
    ds_read_b128 v[20:23], v45
    ds_read_b128 v[24:27], v46
    ds_read_b128 v[28:31], v47
    s_sub_u32 s45, s45, 1
    s_waitcnt lgkmcnt(0)
    s_cbranch_scc1 L_ogo
    v_bitop3_b32 v48, v19, v23, s44 bitop3:0x7e
    v_bitop3_b32 v49, v27, v31, s44 bitop3:0x7e
    v_or_b32 v48, v48, v49
    v_cmp_ne_u32 vcc, 0, v48
    s_cbranch_vccnz L_opoll
L_ogo:
    v_mov_b32 v18, v20
    v_mov_b32 v19, v21
    v_max_f32_dpp v14, v26, v26 quad_perm:[1,0,3,2] row_mask:0xf bank_mask:0xf
    v_mov_b32 v10, v26
    v_mov_b32 v26, v28
    v_mov_b32 v27, v29
    v_mfma_f32_16x16x32_bf16 v[48:51], v[16:19], v[64:67], 0
    v_max_f32_dpp v14, v14, v14 quad_perm:[2,3,0,1] row_mask:0xf bank_mask:0xf
    v_mfma_f32_16x16x32_bf16 v[52:55], v[16:19], v[72:75], 0
    s_nop 0
    v_max_f32_dpp v14, v14, v14 row_half_mirror row_mask:0xf bank_mask:0xf
    v_sub_f32 v10, v10, v14
    v_exp_f32 v10, v10
    v_mfma_f32_16x16x32_bf16 v[56:59], v[16:19], v[80:83], 0
    v_mul_f32 v14, v10, v22
    v_mfma_f32_16x16x32_bf16 v[60:63], v[16:19], v[88:91], 0
    s_nop 0
    v_add_f32_dpp v14, v14, v14 quad_perm:[1,0,3,2] row_mask:0xf bank_mask:0xf
    v_mfma_f32_16x16x32_bf16 v[48:51], v[24:27], v[68:71], v[48:51]
    s_nop 0
    v_add_f32_dpp v14, v14, v14 quad_perm:[2,3,0,1] row_mask:0xf bank_mask:0xf
    v_mfma_f32_16x16x32_bf16 v[52:55], v[24:27], v[76:79], v[52:55]
    s_nop 0
    v_add_f32_dpp v14, v14, v14 row_half_mirror row_mask:0xf bank_mask:0xf
    v_rcp_f32 v14, v14
    v_mfma_f32_16x16x32_bf16 v[56:59], v[24:27], v[84:87], v[56:59]
    v_mul_f32 v10, v10, v14
    v_mov_b32 v14, v10
    v_mfma_f32_16x16x32_bf16 v[60:63], v[24:27], v[92:95], v[60:63]
    s_nop 0
    v_mov_b32_dpp v14, v10 row_ror:12 row_mask:0x2 bank_mask:0xf
    v_mov_b32_dpp v14, v10 row_ror:8 row_mask:0x4 bank_mask:0xf
    v_mov_b32_dpp v14, v10 row_ror:4 row_mask:0x8 bank_mask:0xf
    s_nop 1
    v_fmac_f32_dpp v36, v14, v48 row_newbcast:0 row_mask:0xf bank_mask:0xf
    v_fmac_f32_dpp v37, v14, v52 row_newbcast:0 row_mask:0xf bank_mask:0xf
    v_fmac_f32_dpp v38, v14, v56 row_newbcast:0 row_mask:0xf bank_mask:0xf
    v_fmac_f32_dpp v39, v14, v60 row_newbcast:0 row_mask:0xf bank_mask:0xf
    v_fmac_f32_dpp v36, v14, v49 row_newbcast:1 row_mask:0xf bank_mask:0xf
    v_fmac_f32_dpp v37, v14, v53 row_newbcast:1 row_mask:0xf bank_mask:0xf
    v_fmac_f32_dpp v38, v14, v57 row_newbcast:1 row_mask:0xf bank_mask:0xf
    v_fmac_f32_dpp v39, v14, v61 row_newbcast:1 row_mask:0xf bank_mask:0xf
    v_fmac_f32_dpp v36, v14, v50 row_newbcast:2 row_mask:0xf bank_mask:0xf
    v_fmac_f32_dpp v37, v14, v54 row_newbcast:2 row_mask:0xf bank_mask:0xf
    v_fmac_f32_dpp v38, v14, v58 row_newbcast:2 row_mask:0xf bank_mask:0xf
    v_fmac_f32_dpp v39, v14, v62 row_newbcast:2 row_mask:0xf bank_mask:0xf
    v_fmac_f32_dpp v36, v14, v51 row_newbcast:3 row_mask:0xf bank_mask:0xf
    v_fmac_f32_dpp v37, v14, v55 row_newbcast:3 row_mask:0xf bank_mask:0xf
    v_fmac_f32_dpp v38, v14, v59 row_newbcast:3 row_mask:0xf bank_mask:0xf
    v_fmac_f32_dpp v39, v14, v63 row_newbcast:3 row_mask:0xf bank_mask:0xf
    s_cmp_eq_u32 s50, 3
    v_permlane16_swap_b32 v36, v37
    v_permlane16_swap_b32 v38, v39
    v_add_f32 v32, v36, v37
    v_add_f32 v33, v38, v39
    ds_write_b64 v12, v[32:33] offset:5120
    s_mov_b64 exec, 1
    ds_add_u32 v5, v42 offset:124
    s_cbranch_scc1 L_end
    s_mov_b64 exec, s[94:95]
L_zre:
    ds_read_b32 v43, v5 offset:124
    ds_read2st64_b32 v[24:25], v113 offset0:0 offset1:2
    ds_read2st64_b32 v[26:27], v113 offset0:4 offset1:6
    s_waitcnt lgkmcnt(0)
    v_cmp_gt_u32 vcc, 4, v43
    s_cbranch_vccnz L_zre
    v_add_f32 v24, v24, v25
    v_add_f32 v26, v26, v27
    v_add_f32 v24, v24, v26
    v_cndmask_b32 v24, v115, v24, s[90:91]
    v_cvt_f64_f32 v[26:27], v24
    buffer_atomic_add_f64 v[26:27], v13, s[36:39], s56 offen sc0
    v_cvt_f64_f32 v[28:29], v24
    s_mov_b32 s46, 0x402e0000
    s_waitcnt vmcnt(0)
    v_mov_b32_dpp v30, v27 row_newbcast:7 row_mask:0xf bank_mask:0x3
    v_mov_b32_dpp v30, v27 row_newbcast:15 row_mask:0xf bank_mask:0xc
    v_add_f64 v[26:27], v[26:27], v[28:29]
    v_cmp_eq_u32 vcc, s46, v30
    v_cvt_f32_f64 v26, v[26:27]
    s_and_b64 exec, vcc, s[90:91]
    s_cbranch_execz L_end
    v_cvt_pk_bf16_f32 v26, v26, v26
    buffer_store_short v26, v117, s[40:43], s89 offen
    s_cmp_lg_u32 s56, 264192
    s_cbranch_scc1 L_end
    s_and_b64 exec, exec, 1
    s_cbranch_execz L_end
    buffer_store_dword v34, v5, s[36:39], 0 offen
L_end:
    s_endpgm
.section .rodata,"a"
.p2align 6
.amdhsa_kernel parallel_sum__sliding_block_cached__dense_activation_mish__decode_kernel
  .amdhsa_next_free_vgpr 128
  .amdhsa_next_free_sgpr 100
  .amdhsa_accum_offset 128
  .amdhsa_group_segment_fixed_size 0
  .amdhsa_kernarg_size 96
  .amdhsa_user_sgpr_count 2
  .amdhsa_user_sgpr_kernarg_segment_ptr 1
  .amdhsa_system_sgpr_workgroup_id_x 1
.end_amdhsa_kernel
```
